```python
import torch

def _softmax(x, axis=-1):
    return torch.softmax(x, dim=axis)
def _gelu(x):
    return torch.nn.functional.gelu(x, approximate="tanh")
def _silu(x):
    return torch.nn.functional.silu(x)
def _sigmoid(x):
    return torch.sigmoid(x)
def _layernorm(x, axis=-1, eps=1e-5):
    m = x.mean(dim=axis, keepdim=True)
    v = x.var(dim=axis, keepdim=True, unbiased=False)
    return (x - m) / torch.sqrt(v + eps)
def _scatter_add(tgt, idx, src, axis=0):
    return tgt.clone().index_add_(axis, idx, src)
def _segment_sum(src, seg, n):
    out = torch.zeros((n,) + src.shape[1:], dtype=src.dtype)
    return out.index_add_(0, seg, src)
def _pad(x, pw):
    flat = tuple(v for pair in reversed(pw) for v in pair)
    return torch.nn.functional.pad(x, flat)

kernel_name = 'recurrent_scan__mha_block_cached__geglu_ffn__decode'

def setup_inputs():

    _w = (lambda a: (lambda t: t.to(torch.bfloat16) if t.is_floating_point() else t)(torch.as_tensor(a)))
    def _A_setup():
        B, Sq, D = 8, 1, 512
        H, Sk, Dh = 32, 4096, 128
        return {
            "x": _w((lambda *s: torch.randn(*s, dtype=torch.bfloat16) * 0.05)(B, Sq, D)),
            "k_cache": _w((lambda *s: torch.randn(*s, dtype=torch.bfloat16) * 1.6)(B, H, Sk, Dh)),
            "v_cache": _w((lambda *s: torch.randn(*s, dtype=torch.bfloat16) * 0.2)(B, H, Sk, Dh)),
            "wq": _w((lambda *s: torch.randn(*s, dtype=torch.bfloat16) * 1.6)(D, H * Dh) * (D ** -0.5)),
            "wo": _w((lambda *s: torch.randn(*s, dtype=torch.bfloat16) * 0.2)(H * Dh, D) * ((H * Dh) ** -0.5)),
        }
    _A_in = _A_setup()

    def _B_setup():
        B, S, D, F = 8, 1, 512, 1792
        return {
            "x": _w((lambda *s: torch.randn(*s, dtype=torch.bfloat16) * 0.05)(B, S, D)),
            "w_gate": _w((lambda *s: torch.randn(*s, dtype=torch.bfloat16) * 0.1)(D, F)),
            "w_up": _w((lambda *s: torch.randn(*s, dtype=torch.bfloat16) * 0.1)(D, F)),
            "w_down": _w((lambda *s: torch.randn(*s, dtype=torch.bfloat16) * 0.1)(F, D)),
        }
    _B_in = _B_setup()

    return {
        "A_x": _A_in["x"],
        "A_k_cache": _A_in["k_cache"],
        "A_v_cache": _A_in["v_cache"],
        "A_wq": _A_in["wq"],
        "A_wo": _A_in["wo"],
        "B_x": _B_in["x"],
        "B_w_gate": _B_in["w_gate"],
        "B_w_up": _B_in["w_up"],
        "B_w_down": _B_in["w_down"],
    }

def reference(A_x, A_k_cache, A_v_cache, A_wq, A_wo, B_x, B_w_gate, B_w_up, B_w_down):
    def _A_ref(x, k_cache, v_cache, wq, wo):
        B, Sq, D = x.shape
        H, Dh = 32, 128
        q = (lambda x, *d: x.permute(*d))((x @ wq).reshape(B, Sq, H, Dh), 0, 2, 1, 3)
        scores = torch.einsum("bhqd,bhkd->bhqk", q, k_cache) * (Dh ** -0.5)
        p = _softmax(scores, axis=-1)
        o = torch.einsum("bhqk,bhkd->bhqd", p, v_cache)
        return (lambda x, *d: x.permute(*d))(o, 0, 2, 1, 3).reshape(B, Sq, H * Dh) @ wo

    def _B_ref(x, w_gate, w_up, w_down):
        return (_gelu(x @ w_gate) * (x @ w_up)) @ w_down

    x = A_x
    xn = _layernorm(x, axis=-1)
    s = _A_ref(xn, A_k_cache, A_v_cache, A_wq, A_wo)
    g = _silu(_B_ref(xn, B_w_gate, B_w_up, B_w_down))
    return x + s * g
```

```asm
; @launch grid=(256,1,1) block=(704,1,1) lds=160256
.amdgcn_target "amdgcn-amd-amdhsa--gfx950"
.text
.globl recurrent_scan__mha_block_cached__geglu_ffn__decode_kernel
.p2align 8
.type recurrent_scan__mha_block_cached__geglu_ffn__decode_kernel,@function
recurrent_scan__mha_block_cached__geglu_ffn__decode_kernel:
  s_cmp_ge_u32 s2, 256
  s_cbranch_scc1 L_done
  s_load_dwordx8 s[4:11], s[0:1], 0
  v_lshrrev_b32 v1, 6, v0
  v_and_b32 v2, 63, v0
  v_readfirstlane_b32 s3, v1
  v_lshlrev_b32 v1, 4, v2
  s_and_b32 s36, s2, 7
  s_lshl_b32 s36, s36, 2
  s_bfe_u32 s37, s2, 0x20003
  s_add_u32 s36, s36, s37
  s_lshr_b32 s37, s2, 5
  s_cmp_lg_u32 s3, 0
  s_cbranch_scc1 L_notloader
  s_setprio 3
  s_lshl_b32 s38, s37, 5
  s_add_u32 s38, s38, s36
  s_lshl_b32 s38, s38, 20
  s_mov_b32 s30, 0x100000
  s_mov_b32 s31, 0x20000
  s_mov_b32 s40, 0
  s_mov_b32 s41, 0
  s_mov_b32 m0, 0
  s_waitcnt lgkmcnt(0)
  s_add_u32 s28, s6, s38
  s_addc_u32 s29, s7, 0
  s_add_u32 s32, s8, s38
  s_addc_u32 s33, s9, 0
  v_mov_b32 v7, 0
  buffer_load_dwordx4 v1, s[28:31], s40 offen offset:0 nt lds
  buffer_load_dwordx4 v1, s[28:31], s40 offen offset:1024 nt lds
  buffer_load_dwordx4 v1, s[28:31], s40 offen offset:2048 nt lds
  buffer_load_dwordx4 v1, s[28:31], s40 offen offset:3072 nt lds
  s_add_u32 s40, s40, 4096
  s_add_u32 m0, s41, 4096
  s_nop 0
  buffer_load_dwordx4 v1, s[28:31], s40 offen offset:0 nt lds
  buffer_load_dwordx4 v1, s[28:31], s40 offen offset:1024 nt lds
  buffer_load_dwordx4 v1, s[28:31], s40 offen offset:2048 nt lds
  buffer_load_dwordx4 v1, s[28:31], s40 offen offset:3072 nt lds
  s_add_u32 s40, s40, 4096
  s_add_u32 s41, s41, 8192
  s_cmp_eq_u32 s41, 147456
  s_cselect_b32 s41, 0, s41
  s_mov_b32 m0, s41
  s_nop 0
  buffer_load_dwordx4 v1, s[28:31], s40 offen offset:0 nt lds
  buffer_load_dwordx4 v1, s[28:31], s40 offen offset:1024 nt lds
  buffer_load_dwordx4 v1, s[28:31], s40 offen offset:2048 nt lds
  buffer_load_dwordx4 v1, s[28:31], s40 offen offset:3072 nt lds
  s_add_u32 s40, s40, 4096
  s_add_u32 m0, s41, 4096
  s_nop 0
  buffer_load_dwordx4 v1, s[28:31], s40 offen offset:0 nt lds
  buffer_load_dwordx4 v1, s[28:31], s40 offen offset:1024 nt lds
  buffer_load_dwordx4 v1, s[28:31], s40 offen offset:2048 nt lds
  buffer_load_dwordx4 v1, s[28:31], s40 offen offset:3072 nt lds
  s_add_u32 s40, s40, 4096
  s_add_u32 s41, s41, 8192
  s_cmp_eq_u32 s41, 147456
  s_cselect_b32 s41, 0, s41
  s_mov_b32 m0, s41
  s_nop 0
  buffer_load_dwordx4 v1, s[28:31], s40 offen offset:0 nt lds
  buffer_load_dwordx4 v1, s[28:31], s40 offen offset:1024 nt lds
  buffer_load_dwordx4 v1, s[28:31], s40 offen offset:2048 nt lds
  buffer_load_dwordx4 v1, s[28:31], s40 offen offset:3072 nt lds
  s_add_u32 s40, s40, 4096
  v_mov_b32 v3, 150592
  v_lshl_add_u32 v4, v2, 2, v3
  v_mov_b32 v5, 0
  s_mov_b64 exec, 0xff
  ds_write_b32 v4, v5
  s_mov_b64 exec, -1
  v_mov_b32 v8, 316
  ds_write_b32 v3, v8 offset:12
  s_waitcnt lgkmcnt(0)
  s_barrier
  s_add_u32 m0, s41, 4096
  s_waitcnt vmcnt(19)
  buffer_load_dwordx4 v1, s[28:31], s40 offen offset:0 nt lds
  s_waitcnt vmcnt(19)
  buffer_load_dwordx4 v1, s[28:31], s40 offen offset:1024 nt lds
  s_waitcnt vmcnt(19)
  buffer_load_dwordx4 v1, s[28:31], s40 offen offset:2048 nt lds
  s_waitcnt vmcnt(19)
  buffer_load_dwordx4 v1, s[28:31], s40 offen offset:3072 nt lds
  v_add_u32 v5, 1, v7
  ds_write_b32 v3, v5
  s_add_u32 s40, s40, 4096
  s_add_u32 s41, s41, 8192
  s_cmp_eq_u32 s41, 147456
  s_cselect_b32 s41, 0, s41
  s_mov_b32 m0, s41
  s_waitcnt vmcnt(19)
  buffer_load_dwordx4 v1, s[28:31], s40 offen offset:0 nt lds
  s_waitcnt vmcnt(19)
  buffer_load_dwordx4 v1, s[28:31], s40 offen offset:1024 nt lds
  s_waitcnt vmcnt(19)
  buffer_load_dwordx4 v1, s[28:31], s40 offen offset:2048 nt lds
  s_waitcnt vmcnt(19)
  buffer_load_dwordx4 v1, s[28:31], s40 offen offset:3072 nt lds
  v_add_u32 v5, 2, v7
  ds_write_b32 v3, v5
  s_add_u32 s40, s40, 4096
  s_add_u32 m0, s41, 4096
  s_waitcnt vmcnt(19)
  buffer_load_dwordx4 v1, s[28:31], s40 offen offset:0 nt lds
  s_waitcnt vmcnt(19)
  buffer_load_dwordx4 v1, s[28:31], s40 offen offset:1024 nt lds
  s_waitcnt vmcnt(19)
  buffer_load_dwordx4 v1, s[28:31], s40 offen offset:2048 nt lds
  s_waitcnt vmcnt(19)
  buffer_load_dwordx4 v1, s[28:31], s40 offen offset:3072 nt lds
  v_add_u32 v5, 3, v7
  ds_write_b32 v3, v5
  s_add_u32 s40, s40, 4096
  s_add_u32 s41, s41, 8192
  s_cmp_eq_u32 s41, 147456
  s_cselect_b32 s41, 0, s41
  s_mov_b32 s44, 0
  s_mov_b32 s47, 24
  ds_read_b32 v6, v3 offset:24
  ds_read_b32 v8, v3 offset:12
L_disp:
  v_add_u32 v7, 8, v7
  s_add_u32 s44, s44, 1
  s_cmp_eq_u32 s44, 64
  s_cbranch_scc1 L_drain
  s_cmp_eq_u32 s44, 32
  s_cselect_b32 s28, s32, s28
  s_cselect_b32 s29, s33, s29
  s_cselect_b32 s40, 0, s40
  s_waitcnt lgkmcnt(0)
  v_readfirstlane_b32 s45, v6
  v_readfirstlane_b32 s46, v8
  s_sub_i32 s45, s45, -4
  s_cmp_ge_i32 s45, s44
  s_cbranch_scc0 L_lslow_0
L_lfree_0:
  s_add_i32 s47, s47, s46
  s_cmp_ge_u32 s44, 63
  s_cbranch_scc1 L_c28
  s_cmp_ge_i32 s47, 352
  s_cbranch_scc1 L_k22_6
  s_cmp_ge_i32 s47, 256
  s_cbranch_scc1 L_k16_3
  s_branch L_c13
L_k16_3:
  s_cmp_ge_i32 s47, 304
  s_cbranch_scc1 L_c19
  s_branch L_c16
L_k22_6:
  s_cmp_ge_i32 s47, 400
  s_cbranch_scc1 L_k25_3
  s_branch L_c22
L_k25_3:
  s_cmp_ge_i32 s47, 448
  s_cbranch_scc1 L_c28
  s_branch L_c25
L_c13:
  s_sub_i32 s47, s47, 208
  s_mov_b32 m0, s41
  s_waitcnt vmcnt(12)
  buffer_load_dwordx4 v1, s[28:31], s40 offen offset:0 nt lds
  v_add_u32 v5, -3, v7
  ds_write_b32 v3, v5
  s_waitcnt vmcnt(12)
  buffer_load_dwordx4 v1, s[28:31], s40 offen offset:1024 nt lds
  s_waitcnt vmcnt(12)
  buffer_load_dwordx4 v1, s[28:31], s40 offen offset:2048 nt lds
  s_waitcnt vmcnt(12)
  buffer_load_dwordx4 v1, s[28:31], s40 offen offset:3072 nt lds
  s_add_u32 s40, s40, 4096
  s_add_u32 m0, s41, 4096
  s_waitcnt vmcnt(12)
  buffer_load_dwordx4 v1, s[28:31], s40 offen offset:0 nt lds
  v_add_u32 v5, -2, v7
  ds_write_b32 v3, v5
  ds_read_b32 v6, v3 offset:28
  s_waitcnt vmcnt(12)
  buffer_load_dwordx4 v1, s[28:31], s40 offen offset:1024 nt lds
  s_waitcnt vmcnt(12)
  buffer_load_dwordx4 v1, s[28:31], s40 offen offset:2048 nt lds
  s_waitcnt vmcnt(12)
  buffer_load_dwordx4 v1, s[28:31], s40 offen offset:3072 nt lds
  s_add_u32 s40, s40, 4096
  s_add_u32 s41, s41, 8192
  s_cmp_eq_u32 s41, 147456
  s_cselect_b32 s41, 0, s41
  s_waitcnt lgkmcnt(0)
  v_readfirstlane_b32 s45, v6
  s_sub_i32 s45, s45, -4
  s_cmp_ge_i32 s45, s44
  s_cbranch_scc0 L_lslow13_1
L_lfree13_1:
  s_mov_b32 m0, s41
  s_waitcnt vmcnt(12)
  buffer_load_dwordx4 v1, s[28:31], s40 offen offset:0 nt lds
  v_add_u32 v5, -1, v7
  ds_write_b32 v3, v5
  s_waitcnt vmcnt(12)
  buffer_load_dwordx4 v1, s[28:31], s40 offen offset:1024 nt lds
  s_waitcnt vmcnt(12)
  buffer_load_dwordx4 v1, s[28:31], s40 offen offset:2048 nt lds
  s_waitcnt vmcnt(12)
  buffer_load_dwordx4 v1, s[28:31], s40 offen offset:3072 nt lds
  s_add_u32 s40, s40, 4096
  s_add_u32 m0, s41, 4096
  s_waitcnt vmcnt(12)
  buffer_load_dwordx4 v1, s[28:31], s40 offen offset:0 nt lds
  v_add_u32 v5, 0, v7
  ds_write_b32 v3, v5
  ds_read_b32 v6, v3 offset:16
  s_waitcnt vmcnt(12)
  buffer_load_dwordx4 v1, s[28:31], s40 offen offset:1024 nt lds
  s_waitcnt vmcnt(12)
  buffer_load_dwordx4 v1, s[28:31], s40 offen offset:2048 nt lds
  s_waitcnt vmcnt(12)
  buffer_load_dwordx4 v1, s[28:31], s40 offen offset:3072 nt lds
  s_add_u32 s40, s40, 4096
  s_add_u32 s41, s41, 8192
  s_cmp_eq_u32 s41, 147456
  s_cselect_b32 s41, 0, s41
  s_waitcnt lgkmcnt(0)
  v_readfirstlane_b32 s45, v6
  s_sub_i32 s45, s45, -3
  s_cmp_ge_i32 s45, s44
  s_cbranch_scc0 L_lslow13_2
L_lfree13_2:
  s_mov_b32 m0, s41
  s_waitcnt vmcnt(12)
  buffer_load_dwordx4 v1, s[28:31], s40 offen offset:0 nt lds
  v_add_u32 v5, 1, v7
  ds_write_b32 v3, v5
  s_waitcnt vmcnt(12)
  buffer_load_dwordx4 v1, s[28:31], s40 offen offset:1024 nt lds
  s_waitcnt vmcnt(12)
  buffer_load_dwordx4 v1, s[28:31], s40 offen offset:2048 nt lds
  s_waitcnt vmcnt(12)
  buffer_load_dwordx4 v1, s[28:31], s40 offen offset:3072 nt lds
  s_add_u32 s40, s40, 4096
  s_add_u32 m0, s41, 4096
  s_waitcnt vmcnt(12)
  buffer_load_dwordx4 v1, s[28:31], s40 offen offset:0 nt lds
  v_add_u32 v5, 2, v7
  ds_write_b32 v3, v5
  ds_read_b32 v6, v3 offset:20
  s_waitcnt vmcnt(12)
  buffer_load_dwordx4 v1, s[28:31], s40 offen offset:1024 nt lds
  s_waitcnt vmcnt(12)
  buffer_load_dwordx4 v1, s[28:31], s40 offen offset:2048 nt lds
  s_waitcnt vmcnt(12)
  buffer_load_dwordx4 v1, s[28:31], s40 offen offset:3072 nt lds
  s_add_u32 s40, s40, 4096
  s_add_u32 s41, s41, 8192
  s_cmp_eq_u32 s41, 147456
  s_cselect_b32 s41, 0, s41
  s_waitcnt lgkmcnt(0)
  v_readfirstlane_b32 s45, v6
  s_sub_i32 s45, s45, -3
  s_cmp_ge_i32 s45, s44
  s_cbranch_scc0 L_lslow13_3
L_lfree13_3:
  s_mov_b32 m0, s41
  s_waitcnt vmcnt(12)
  buffer_load_dwordx4 v1, s[28:31], s40 offen offset:0 nt lds
  v_add_u32 v5, 3, v7
  ds_write_b32 v3, v5
  s_waitcnt vmcnt(12)
  buffer_load_dwordx4 v1, s[28:31], s40 offen offset:1024 nt lds
  s_waitcnt vmcnt(12)
  buffer_load_dwordx4 v1, s[28:31], s40 offen offset:2048 nt lds
  s_waitcnt vmcnt(12)
  buffer_load_dwordx4 v1, s[28:31], s40 offen offset:3072 nt lds
  s_add_u32 s40, s40, 4096
  s_add_u32 m0, s41, 4096
  s_waitcnt vmcnt(12)
  buffer_load_dwordx4 v1, s[28:31], s40 offen offset:0 nt lds
  v_add_u32 v5, 4, v7
  ds_write_b32 v3, v5
  ds_read_b32 v6, v3 offset:24
  ds_read_b32 v8, v3 offset:12
  s_waitcnt vmcnt(12)
  buffer_load_dwordx4 v1, s[28:31], s40 offen offset:1024 nt lds
  s_waitcnt vmcnt(12)
  buffer_load_dwordx4 v1, s[28:31], s40 offen offset:2048 nt lds
  s_waitcnt vmcnt(12)
  buffer_load_dwordx4 v1, s[28:31], s40 offen offset:3072 nt lds
  s_add_u32 s40, s40, 4096
  s_add_u32 s41, s41, 8192
  s_cmp_eq_u32 s41, 147456
  s_cselect_b32 s41, 0, s41
  s_branch L_disp
L_c16:
  s_sub_i32 s47, s47, 256
  s_mov_b32 m0, s41
  s_waitcnt vmcnt(15)
  buffer_load_dwordx4 v1, s[28:31], s40 offen offset:0 nt lds
  s_waitcnt vmcnt(15)
  buffer_load_dwordx4 v1, s[28:31], s40 offen offset:1024 nt lds
  s_waitcnt vmcnt(15)
  buffer_load_dwordx4 v1, s[28:31], s40 offen offset:2048 nt lds
  s_waitcnt vmcnt(15)
  buffer_load_dwordx4 v1, s[28:31], s40 offen offset:3072 nt lds
  v_add_u32 v5, -3, v7
  ds_write_b32 v3, v5
  s_add_u32 s40, s40, 4096
  s_add_u32 m0, s41, 4096
  s_waitcnt vmcnt(15)
  buffer_load_dwordx4 v1, s[28:31], s40 offen offset:0 nt lds
  ds_read_b32 v6, v3 offset:28
  s_waitcnt vmcnt(15)
  buffer_load_dwordx4 v1, s[28:31], s40 offen offset:1024 nt lds
  s_waitcnt vmcnt(15)
  buffer_load_dwordx4 v1, s[28:31], s40 offen offset:2048 nt lds
  s_waitcnt vmcnt(15)
  buffer_load_dwordx4 v1, s[28:31], s40 offen offset:3072 nt lds
  v_add_u32 v5, -2, v7
  ds_write_b32 v3, v5
  s_add_u32 s40, s40, 4096
  s_add_u32 s41, s41, 8192
  s_cmp_eq_u32 s41, 147456
  s_cselect_b32 s41, 0, s41
  s_waitcnt lgkmcnt(1)
  v_readfirstlane_b32 s45, v6
  s_sub_i32 s45, s45, -4
  s_cmp_ge_i32 s45, s44
  s_cbranch_scc0 L_lslow16_1
L_lfree16_1:
  s_mov_b32 m0, s41
  s_waitcnt vmcnt(15)
  buffer_load_dwordx4 v1, s[28:31], s40 offen offset:0 nt lds
  s_waitcnt vmcnt(15)
  buffer_load_dwordx4 v1, s[28:31], s40 offen offset:1024 nt lds
  s_waitcnt vmcnt(15)
  buffer_load_dwordx4 v1, s[28:31], s40 offen offset:2048 nt lds
  s_waitcnt vmcnt(15)
  buffer_load_dwordx4 v1, s[28:31], s40 offen offset:3072 nt lds
  v_add_u32 v5, -1, v7
  ds_write_b32 v3, v5
  s_add_u32 s40, s40, 4096
  s_add_u32 m0, s41, 4096
  s_waitcnt vmcnt(15)
  buffer_load_dwordx4 v1, s[28:31], s40 offen offset:0 nt lds
  ds_read_b32 v6, v3 offset:16
  s_waitcnt vmcnt(15)
  buffer_load_dwordx4 v1, s[28:31], s40 offen offset:1024 nt lds
  s_waitcnt vmcnt(15)
  buffer_load_dwordx4 v1, s[28:31], s40 offen offset:2048 nt lds
  s_waitcnt vmcnt(15)
  buffer_load_dwordx4 v1, s[28:31], s40 offen offset:3072 nt lds
  v_add_u32 v5, 0, v7
  ds_write_b32 v3, v5
  s_add_u32 s40, s40, 4096
  s_add_u32 s41, s41, 8192
  s_cmp_eq_u32 s41, 147456
  s_cselect_b32 s41, 0, s41
  s_waitcnt lgkmcnt(1)
  v_readfirstlane_b32 s45, v6
  s_sub_i32 s45, s45, -3
  s_cmp_ge_i32 s45, s44
  s_cbranch_scc0 L_lslow16_2
L_lfree16_2:
  s_mov_b32 m0, s41
  s_waitcnt vmcnt(15)
  buffer_load_dwordx4 v1, s[28:31], s40 offen offset:0 nt lds
  s_waitcnt vmcnt(15)
  buffer_load_dwordx4 v1, s[28:31], s40 offen offset:1024 nt lds
  s_waitcnt vmcnt(15)
  buffer_load_dwordx4 v1, s[28:31], s40 offen offset:2048 nt lds
  s_waitcnt vmcnt(15)
  buffer_load_dwordx4 v1, s[28:31], s40 offen offset:3072 nt lds
  v_add_u32 v5, 1, v7
  ds_write_b32 v3, v5
  s_add_u32 s40, s40, 4096
  s_add_u32 m0, s41, 4096
  s_waitcnt vmcnt(15)
  buffer_load_dwordx4 v1, s[28:31], s40 offen offset:0 nt lds
  ds_read_b32 v6, v3 offset:20
  s_waitcnt vmcnt(15)
  buffer_load_dwordx4 v1, s[28:31], s40 offen offset:1024 nt lds
  s_waitcnt vmcnt(15)
  buffer_load_dwordx4 v1, s[28:31], s40 offen offset:2048 nt lds
  s_waitcnt vmcnt(15)
  buffer_load_dwordx4 v1, s[28:31], s40 offen offset:3072 nt lds
  v_add_u32 v5, 2, v7
  ds_write_b32 v3, v5
  s_add_u32 s40, s40, 4096
  s_add_u32 s41, s41, 8192
  s_cmp_eq_u32 s41, 147456
  s_cselect_b32 s41, 0, s41
  s_waitcnt lgkmcnt(1)
  v_readfirstlane_b32 s45, v6
  s_sub_i32 s45, s45, -3
  s_cmp_ge_i32 s45, s44
  s_cbranch_scc0 L_lslow16_3
L_lfree16_3:
  s_mov_b32 m0, s41
  s_waitcnt vmcnt(15)
  buffer_load_dwordx4 v1, s[28:31], s40 offen offset:0 nt lds
  s_waitcnt vmcnt(15)
  buffer_load_dwordx4 v1, s[28:31], s40 offen offset:1024 nt lds
  s_waitcnt vmcnt(15)
  buffer_load_dwordx4 v1, s[28:31], s40 offen offset:2048 nt lds
  s_waitcnt vmcnt(15)
  buffer_load_dwordx4 v1, s[28:31], s40 offen offset:3072 nt lds
  v_add_u32 v5, 3, v7
  ds_write_b32 v3, v5
  s_add_u32 s40, s40, 4096
  s_add_u32 m0, s41, 4096
  s_waitcnt vmcnt(15)
  buffer_load_dwordx4 v1, s[28:31], s40 offen offset:0 nt lds
  ds_read_b32 v6, v3 offset:24
  ds_read_b32 v8, v3 offset:12
  s_waitcnt vmcnt(15)
  buffer_load_dwordx4 v1, s[28:31], s40 offen offset:1024 nt lds
  s_waitcnt vmcnt(15)
  buffer_load_dwordx4 v1, s[28:31], s40 offen offset:2048 nt lds
  s_waitcnt vmcnt(15)
  buffer_load_dwordx4 v1, s[28:31], s40 offen offset:3072 nt lds
  v_add_u32 v5, 4, v7
  ds_write_b32 v3, v5
  s_add_u32 s40, s40, 4096
  s_add_u32 s41, s41, 8192
  s_cmp_eq_u32 s41, 147456
  s_cselect_b32 s41, 0, s41
  s_branch L_disp
L_c19:
  s_sub_i32 s47, s47, 304
  s_mov_b32 m0, s41
  s_waitcnt vmcnt(18)
  buffer_load_dwordx4 v1, s[28:31], s40 offen offset:0 nt lds
  s_waitcnt vmcnt(18)
  buffer_load_dwordx4 v1, s[28:31], s40 offen offset:1024 nt lds
  s_waitcnt vmcnt(18)
  buffer_load_dwordx4 v1, s[28:31], s40 offen offset:2048 nt lds
  v_add_u32 v5, -4, v7
  ds_write_b32 v3, v5
  s_waitcnt vmcnt(18)
  buffer_load_dwordx4 v1, s[28:31], s40 offen offset:3072 nt lds
  s_add_u32 s40, s40, 4096
  s_add_u32 m0, s41, 4096
  s_waitcnt vmcnt(18)
  buffer_load_dwordx4 v1, s[28:31], s40 offen offset:0 nt lds
  ds_read_b32 v6, v3 offset:28
  s_waitcnt vmcnt(18)
  buffer_load_dwordx4 v1, s[28:31], s40 offen offset:1024 nt lds
  s_waitcnt vmcnt(18)
  buffer_load_dwordx4 v1, s[28:31], s40 offen offset:2048 nt lds
  v_add_u32 v5, -3, v7
  ds_write_b32 v3, v5
  s_waitcnt vmcnt(18)
  buffer_load_dwordx4 v1, s[28:31], s40 offen offset:3072 nt lds
  s_add_u32 s40, s40, 4096
  s_add_u32 s41, s41, 8192
  s_cmp_eq_u32 s41, 147456
  s_cselect_b32 s41, 0, s41
  s_waitcnt lgkmcnt(1)
  v_readfirstlane_b32 s45, v6
  s_sub_i32 s45, s45, -4
  s_cmp_ge_i32 s45, s44
  s_cbranch_scc0 L_lslow19_1
L_lfree19_1:
  s_mov_b32 m0, s41
  s_waitcnt vmcnt(18)
  buffer_load_dwordx4 v1, s[28:31], s40 offen offset:0 nt lds
  s_waitcnt vmcnt(18)
  buffer_load_dwordx4 v1, s[28:31], s40 offen offset:1024 nt lds
  s_waitcnt vmcnt(18)
  buffer_load_dwordx4 v1, s[28:31], s40 offen offset:2048 nt lds
  v_add_u32 v5, -2, v7
  ds_write_b32 v3, v5
  s_waitcnt vmcnt(18)
  buffer_load_dwordx4 v1, s[28:31], s40 offen offset:3072 nt lds
  s_add_u32 s40, s40, 4096
  s_add_u32 m0, s41, 4096
  s_waitcnt vmcnt(18)
  buffer_load_dwordx4 v1, s[28:31], s40 offen offset:0 nt lds
  ds_read_b32 v6, v3 offset:16
  s_waitcnt vmcnt(18)
  buffer_load_dwordx4 v1, s[28:31], s40 offen offset:1024 nt lds
  s_waitcnt vmcnt(18)
  buffer_load_dwordx4 v1, s[28:31], s40 offen offset:2048 nt lds
  v_add_u32 v5, -1, v7
  ds_write_b32 v3, v5
  s_waitcnt vmcnt(18)
  buffer_load_dwordx4 v1, s[28:31], s40 offen offset:3072 nt lds
  s_add_u32 s40, s40, 4096
  s_add_u32 s41, s41, 8192
  s_cmp_eq_u32 s41, 147456
  s_cselect_b32 s41, 0, s41
  s_waitcnt lgkmcnt(1)
  v_readfirstlane_b32 s45, v6
  s_sub_i32 s45, s45, -3
  s_cmp_ge_i32 s45, s44
  s_cbranch_scc0 L_lslow19_2
L_lfree19_2:
  s_mov_b32 m0, s41
  s_waitcnt vmcnt(18)
  buffer_load_dwordx4 v1, s[28:31], s40 offen offset:0 nt lds
  s_waitcnt vmcnt(18)
  buffer_load_dwordx4 v1, s[28:31], s40 offen offset:1024 nt lds
  s_waitcnt vmcnt(18)
  buffer_load_dwordx4 v1, s[28:31], s40 offen offset:2048 nt lds
  v_add_u32 v5, 0, v7
  ds_write_b32 v3, v5
  s_waitcnt vmcnt(18)
  buffer_load_dwordx4 v1, s[28:31], s40 offen offset:3072 nt lds
  s_add_u32 s40, s40, 4096
  s_add_u32 m0, s41, 4096
  s_waitcnt vmcnt(18)
  buffer_load_dwordx4 v1, s[28:31], s40 offen offset:0 nt lds
  ds_read_b32 v6, v3 offset:20
  s_waitcnt vmcnt(18)
  buffer_load_dwordx4 v1, s[28:31], s40 offen offset:1024 nt lds
  s_waitcnt vmcnt(18)
  buffer_load_dwordx4 v1, s[28:31], s40 offen offset:2048 nt lds
  v_add_u32 v5, 1, v7
  ds_write_b32 v3, v5
  s_waitcnt vmcnt(18)
  buffer_load_dwordx4 v1, s[28:31], s40 offen offset:3072 nt lds
  s_add_u32 s40, s40, 4096
  s_add_u32 s41, s41, 8192
  s_cmp_eq_u32 s41, 147456
  s_cselect_b32 s41, 0, s41
  s_waitcnt lgkmcnt(1)
  v_readfirstlane_b32 s45, v6
  s_sub_i32 s45, s45, -3
  s_cmp_ge_i32 s45, s44
  s_cbranch_scc0 L_lslow19_3
L_lfree19_3:
  s_mov_b32 m0, s41
  s_waitcnt vmcnt(18)
  buffer_load_dwordx4 v1, s[28:31], s40 offen offset:0 nt lds
  s_waitcnt vmcnt(18)
  buffer_load_dwordx4 v1, s[28:31], s40 offen offset:1024 nt lds
  s_waitcnt vmcnt(18)
  buffer_load_dwordx4 v1, s[28:31], s40 offen offset:2048 nt lds
  v_add_u32 v5, 2, v7
  ds_write_b32 v3, v5
  s_waitcnt vmcnt(18)
  buffer_load_dwordx4 v1, s[28:31], s40 offen offset:3072 nt lds
  s_add_u32 s40, s40, 4096
  s_add_u32 m0, s41, 4096
  s_waitcnt vmcnt(18)
  buffer_load_dwordx4 v1, s[28:31], s40 offen offset:0 nt lds
  ds_read_b32 v6, v3 offset:24
  ds_read_b32 v8, v3 offset:12
  s_waitcnt vmcnt(18)
  buffer_load_dwordx4 v1, s[28:31], s40 offen offset:1024 nt lds
  s_waitcnt vmcnt(18)
  buffer_load_dwordx4 v1, s[28:31], s40 offen offset:2048 nt lds
  v_add_u32 v5, 3, v7
  ds_write_b32 v3, v5
  s_waitcnt vmcnt(18)
  buffer_load_dwordx4 v1, s[28:31], s40 offen offset:3072 nt lds
  s_add_u32 s40, s40, 4096
  s_add_u32 s41, s41, 8192
  s_cmp_eq_u32 s41, 147456
  s_cselect_b32 s41, 0, s41
  s_branch L_disp
L_c22:
  s_sub_i32 s47, s47, 352
  s_mov_b32 m0, s41
  s_waitcnt vmcnt(21)
  buffer_load_dwordx4 v1, s[28:31], s40 offen offset:0 nt lds
  s_waitcnt vmcnt(21)
  buffer_load_dwordx4 v1, s[28:31], s40 offen offset:1024 nt lds
  v_add_u32 v5, -5, v7
  ds_write_b32 v3, v5
  s_waitcnt vmcnt(21)
  buffer_load_dwordx4 v1, s[28:31], s40 offen offset:2048 nt lds
  s_waitcnt vmcnt(21)
  buffer_load_dwordx4 v1, s[28:31], s40 offen offset:3072 nt lds
  s_add_u32 s40, s40, 4096
  s_add_u32 m0, s41, 4096
  s_waitcnt vmcnt(21)
  buffer_load_dwordx4 v1, s[28:31], s40 offen offset:0 nt lds
  ds_read_b32 v6, v3 offset:28
  s_waitcnt vmcnt(21)
  buffer_load_dwordx4 v1, s[28:31], s40 offen offset:1024 nt lds
  v_add_u32 v5, -4, v7
  ds_write_b32 v3, v5
  s_waitcnt vmcnt(21)
  buffer_load_dwordx4 v1, s[28:31], s40 offen offset:2048 nt lds
  s_waitcnt vmcnt(21)
  buffer_load_dwordx4 v1, s[28:31], s40 offen offset:3072 nt lds
  s_add_u32 s40, s40, 4096
  s_add_u32 s41, s41, 8192
  s_cmp_eq_u32 s41, 147456
  s_cselect_b32 s41, 0, s41
  s_waitcnt lgkmcnt(1)
  v_readfirstlane_b32 s45, v6
  s_sub_i32 s45, s45, -4
  s_cmp_ge_i32 s45, s44
  s_cbranch_scc0 L_lslow22_1
L_lfree22_1:
  s_mov_b32 m0, s41
  s_waitcnt vmcnt(21)
  buffer_load_dwordx4 v1, s[28:31], s40 offen offset:0 nt lds
  s_waitcnt vmcnt(21)
  buffer_load_dwordx4 v1, s[28:31], s40 offen offset:1024 nt lds
  v_add_u32 v5, -3, v7
  ds_write_b32 v3, v5
  s_waitcnt vmcnt(21)
  buffer_load_dwordx4 v1, s[28:31], s40 offen offset:2048 nt lds
  s_waitcnt vmcnt(21)
  buffer_load_dwordx4 v1, s[28:31], s40 offen offset:3072 nt lds
  s_add_u32 s40, s40, 4096
  s_add_u32 m0, s41, 4096
  s_waitcnt vmcnt(21)
  buffer_load_dwordx4 v1, s[28:31], s40 offen offset:0 nt lds
  ds_read_b32 v6, v3 offset:16
  s_waitcnt vmcnt(21)
  buffer_load_dwordx4 v1, s[28:31], s40 offen offset:1024 nt lds
  v_add_u32 v5, -2, v7
  ds_write_b32 v3, v5
  s_waitcnt vmcnt(21)
  buffer_load_dwordx4 v1, s[28:31], s40 offen offset:2048 nt lds
  s_waitcnt vmcnt(21)
  buffer_load_dwordx4 v1, s[28:31], s40 offen offset:3072 nt lds
  s_add_u32 s40, s40, 4096
  s_add_u32 s41, s41, 8192
  s_cmp_eq_u32 s41, 147456
  s_cselect_b32 s41, 0, s41
  s_waitcnt lgkmcnt(1)
  v_readfirstlane_b32 s45, v6
  s_sub_i32 s45, s45, -3
  s_cmp_ge_i32 s45, s44
  s_cbranch_scc0 L_lslow22_2
L_lfree22_2:
  s_mov_b32 m0, s41
  s_waitcnt vmcnt(21)
  buffer_load_dwordx4 v1, s[28:31], s40 offen offset:0 nt lds
  s_waitcnt vmcnt(21)
  buffer_load_dwordx4 v1, s[28:31], s40 offen offset:1024 nt lds
  v_add_u32 v5, -1, v7
  ds_write_b32 v3, v5
  s_waitcnt vmcnt(21)
  buffer_load_dwordx4 v1, s[28:31], s40 offen offset:2048 nt lds
  s_waitcnt vmcnt(21)
  buffer_load_dwordx4 v1, s[28:31], s40 offen offset:3072 nt lds
  s_add_u32 s40, s40, 4096
  s_add_u32 m0, s41, 4096
  s_waitcnt vmcnt(21)
  buffer_load_dwordx4 v1, s[28:31], s40 offen offset:0 nt lds
  ds_read_b32 v6, v3 offset:20
  s_waitcnt vmcnt(21)
  buffer_load_dwordx4 v1, s[28:31], s40 offen offset:1024 nt lds
  v_add_u32 v5, 0, v7
  ds_write_b32 v3, v5
  s_waitcnt vmcnt(21)
  buffer_load_dwordx4 v1, s[28:31], s40 offen offset:2048 nt lds
  s_waitcnt vmcnt(21)
  buffer_load_dwordx4 v1, s[28:31], s40 offen offset:3072 nt lds
  s_add_u32 s40, s40, 4096
  s_add_u32 s41, s41, 8192
  s_cmp_eq_u32 s41, 147456
  s_cselect_b32 s41, 0, s41
  s_waitcnt lgkmcnt(1)
  v_readfirstlane_b32 s45, v6
  s_sub_i32 s45, s45, -3
  s_cmp_ge_i32 s45, s44
  s_cbranch_scc0 L_lslow22_3
L_lfree22_3:
  s_mov_b32 m0, s41
  s_waitcnt vmcnt(21)
  buffer_load_dwordx4 v1, s[28:31], s40 offen offset:0 nt lds
  s_waitcnt vmcnt(21)
  buffer_load_dwordx4 v1, s[28:31], s40 offen offset:1024 nt lds
  v_add_u32 v5, 1, v7
  ds_write_b32 v3, v5
  s_waitcnt vmcnt(21)
  buffer_load_dwordx4 v1, s[28:31], s40 offen offset:2048 nt lds
  s_waitcnt vmcnt(21)
  buffer_load_dwordx4 v1, s[28:31], s40 offen offset:3072 nt lds
  s_add_u32 s40, s40, 4096
  s_add_u32 m0, s41, 4096
  s_waitcnt vmcnt(21)
  buffer_load_dwordx4 v1, s[28:31], s40 offen offset:0 nt lds
  ds_read_b32 v6, v3 offset:24
  ds_read_b32 v8, v3 offset:12
  s_waitcnt vmcnt(21)
  buffer_load_dwordx4 v1, s[28:31], s40 offen offset:1024 nt lds
  v_add_u32 v5, 2, v7
  ds_write_b32 v3, v5
  s_waitcnt vmcnt(21)
  buffer_load_dwordx4 v1, s[28:31], s40 offen offset:2048 nt lds
  s_waitcnt vmcnt(21)
  buffer_load_dwordx4 v1, s[28:31], s40 offen offset:3072 nt lds
  s_add_u32 s40, s40, 4096
  s_add_u32 s41, s41, 8192
  s_cmp_eq_u32 s41, 147456
  s_cselect_b32 s41, 0, s41
  s_branch L_disp
L_c25:
  s_sub_i32 s47, s47, 400
  s_mov_b32 m0, s41
  s_waitcnt vmcnt(24)
  buffer_load_dwordx4 v1, s[28:31], s40 offen offset:0 nt lds
  v_add_u32 v5, -6, v7
  ds_write_b32 v3, v5
  s_waitcnt vmcnt(24)
  buffer_load_dwordx4 v1, s[28:31], s40 offen offset:1024 nt lds
  s_waitcnt vmcnt(24)
  buffer_load_dwordx4 v1, s[28:31], s40 offen offset:2048 nt lds
  s_waitcnt vmcnt(24)
  buffer_load_dwordx4 v1, s[28:31], s40 offen offset:3072 nt lds
  s_add_u32 s40, s40, 4096
  s_add_u32 m0, s41, 4096
  s_waitcnt vmcnt(24)
  buffer_load_dwordx4 v1, s[28:31], s40 offen offset:0 nt lds
  v_add_u32 v5, -5, v7
  ds_write_b32 v3, v5
  ds_read_b32 v6, v3 offset:28
  s_waitcnt vmcnt(24)
  buffer_load_dwordx4 v1, s[28:31], s40 offen offset:1024 nt lds
  s_waitcnt vmcnt(24)
  buffer_load_dwordx4 v1, s[28:31], s40 offen offset:2048 nt lds
  s_waitcnt vmcnt(24)
  buffer_load_dwordx4 v1, s[28:31], s40 offen offset:3072 nt lds
  s_add_u32 s40, s40, 4096
  s_add_u32 s41, s41, 8192
  s_cmp_eq_u32 s41, 147456
  s_cselect_b32 s41, 0, s41
  s_waitcnt lgkmcnt(0)
  v_readfirstlane_b32 s45, v6
  s_sub_i32 s45, s45, -4
  s_cmp_ge_i32 s45, s44
  s_cbranch_scc0 L_lslow25_1
L_lfree25_1:
  s_mov_b32 m0, s41
  s_waitcnt vmcnt(24)
  buffer_load_dwordx4 v1, s[28:31], s40 offen offset:0 nt lds
  v_add_u32 v5, -4, v7
  ds_write_b32 v3, v5
  s_waitcnt vmcnt(24)
  buffer_load_dwordx4 v1, s[28:31], s40 offen offset:1024 nt lds
  s_waitcnt vmcnt(24)
  buffer_load_dwordx4 v1, s[28:31], s40 offen offset:2048 nt lds
  s_waitcnt vmcnt(24)
  buffer_load_dwordx4 v1, s[28:31], s40 offen offset:3072 nt lds
  s_add_u32 s40, s40, 4096
  s_add_u32 m0, s41, 4096
  s_waitcnt vmcnt(24)
  buffer_load_dwordx4 v1, s[28:31], s40 offen offset:0 nt lds
  v_add_u32 v5, -3, v7
  ds_write_b32 v3, v5
  ds_read_b32 v6, v3 offset:16
  s_waitcnt vmcnt(24)
  buffer_load_dwordx4 v1, s[28:31], s40 offen offset:1024 nt lds
  s_waitcnt vmcnt(24)
  buffer_load_dwordx4 v1, s[28:31], s40 offen offset:2048 nt lds
  s_waitcnt vmcnt(24)
  buffer_load_dwordx4 v1, s[28:31], s40 offen offset:3072 nt lds
  s_add_u32 s40, s40, 4096
  s_add_u32 s41, s41, 8192
  s_cmp_eq_u32 s41, 147456
  s_cselect_b32 s41, 0, s41
  s_waitcnt lgkmcnt(0)
  v_readfirstlane_b32 s45, v6
  s_sub_i32 s45, s45, -3
  s_cmp_ge_i32 s45, s44
  s_cbranch_scc0 L_lslow25_2
L_lfree25_2:
  s_mov_b32 m0, s41
  s_waitcnt vmcnt(24)
  buffer_load_dwordx4 v1, s[28:31], s40 offen offset:0 nt lds
  v_add_u32 v5, -2, v7
  ds_write_b32 v3, v5
  s_waitcnt vmcnt(24)
  buffer_load_dwordx4 v1, s[28:31], s40 offen offset:1024 nt lds
  s_waitcnt vmcnt(24)
  buffer_load_dwordx4 v1, s[28:31], s40 offen offset:2048 nt lds
  s_waitcnt vmcnt(24)
  buffer_load_dwordx4 v1, s[28:31], s40 offen offset:3072 nt lds
  s_add_u32 s40, s40, 4096
  s_add_u32 m0, s41, 4096
  s_waitcnt vmcnt(24)
  buffer_load_dwordx4 v1, s[28:31], s40 offen offset:0 nt lds
  v_add_u32 v5, -1, v7
  ds_write_b32 v3, v5
  ds_read_b32 v6, v3 offset:20
  s_waitcnt vmcnt(24)
  buffer_load_dwordx4 v1, s[28:31], s40 offen offset:1024 nt lds
  s_waitcnt vmcnt(24)
  buffer_load_dwordx4 v1, s[28:31], s40 offen offset:2048 nt lds
  s_waitcnt vmcnt(24)
  buffer_load_dwordx4 v1, s[28:31], s40 offen offset:3072 nt lds
  s_add_u32 s40, s40, 4096
  s_add_u32 s41, s41, 8192
  s_cmp_eq_u32 s41, 147456
  s_cselect_b32 s41, 0, s41
  s_waitcnt lgkmcnt(0)
  v_readfirstlane_b32 s45, v6
  s_sub_i32 s45, s45, -3
  s_cmp_ge_i32 s45, s44
  s_cbranch_scc0 L_lslow25_3
L_lfree25_3:
  s_mov_b32 m0, s41
  s_waitcnt vmcnt(24)
  buffer_load_dwordx4 v1, s[28:31], s40 offen offset:0 nt lds
  v_add_u32 v5, 0, v7
  ds_write_b32 v3, v5
  s_waitcnt vmcnt(24)
  buffer_load_dwordx4 v1, s[28:31], s40 offen offset:1024 nt lds
  s_waitcnt vmcnt(24)
  buffer_load_dwordx4 v1, s[28:31], s40 offen offset:2048 nt lds
  s_waitcnt vmcnt(24)
  buffer_load_dwordx4 v1, s[28:31], s40 offen offset:3072 nt lds
  s_add_u32 s40, s40, 4096
  s_add_u32 m0, s41, 4096
  s_waitcnt vmcnt(24)
  buffer_load_dwordx4 v1, s[28:31], s40 offen offset:0 nt lds
  v_add_u32 v5, 1, v7
  ds_write_b32 v3, v5
  ds_read_b32 v6, v3 offset:24
  ds_read_b32 v8, v3 offset:12
  s_waitcnt vmcnt(24)
  buffer_load_dwordx4 v1, s[28:31], s40 offen offset:1024 nt lds
  s_waitcnt vmcnt(24)
  buffer_load_dwordx4 v1, s[28:31], s40 offen offset:2048 nt lds
  s_waitcnt vmcnt(24)
  buffer_load_dwordx4 v1, s[28:31], s40 offen offset:3072 nt lds
  s_add_u32 s40, s40, 4096
  s_add_u32 s41, s41, 8192
  s_cmp_eq_u32 s41, 147456
  s_cselect_b32 s41, 0, s41
  s_branch L_disp
L_c28:
  s_sub_i32 s47, s47, 448
  s_mov_b32 m0, s41
  s_waitcnt vmcnt(27)
  buffer_load_dwordx4 v1, s[28:31], s40 offen offset:0 nt lds
  s_waitcnt vmcnt(27)
  buffer_load_dwordx4 v1, s[28:31], s40 offen offset:1024 nt lds
  s_waitcnt vmcnt(27)
  buffer_load_dwordx4 v1, s[28:31], s40 offen offset:2048 nt lds
  s_waitcnt vmcnt(27)
  buffer_load_dwordx4 v1, s[28:31], s40 offen offset:3072 nt lds
  v_add_u32 v5, -6, v7
  ds_write_b32 v3, v5
  s_add_u32 s40, s40, 4096
  s_add_u32 m0, s41, 4096
  s_waitcnt vmcnt(27)
  buffer_load_dwordx4 v1, s[28:31], s40 offen offset:0 nt lds
  ds_read_b32 v6, v3 offset:28
  s_waitcnt vmcnt(27)
  buffer_load_dwordx4 v1, s[28:31], s40 offen offset:1024 nt lds
  s_waitcnt vmcnt(27)
  buffer_load_dwordx4 v1, s[28:31], s40 offen offset:2048 nt lds
  s_waitcnt vmcnt(27)
  buffer_load_dwordx4 v1, s[28:31], s40 offen offset:3072 nt lds
  v_add_u32 v5, -5, v7
  ds_write_b32 v3, v5
  s_add_u32 s40, s40, 4096
  s_add_u32 s41, s41, 8192
  s_cmp_eq_u32 s41, 147456
  s_cselect_b32 s41, 0, s41
  s_waitcnt lgkmcnt(1)
  v_readfirstlane_b32 s45, v6
  s_sub_i32 s45, s45, -4
  s_cmp_ge_i32 s45, s44
  s_cbranch_scc0 L_lslow28_1
L_lfree28_1:
  s_mov_b32 m0, s41
  s_waitcnt vmcnt(27)
  buffer_load_dwordx4 v1, s[28:31], s40 offen offset:0 nt lds
  s_waitcnt vmcnt(27)
  buffer_load_dwordx4 v1, s[28:31], s40 offen offset:1024 nt lds
  s_waitcnt vmcnt(27)
  buffer_load_dwordx4 v1, s[28:31], s40 offen offset:2048 nt lds
  s_waitcnt vmcnt(27)
  buffer_load_dwordx4 v1, s[28:31], s40 offen offset:3072 nt lds
  v_add_u32 v5, -4, v7
  ds_write_b32 v3, v5
  s_add_u32 s40, s40, 4096
  s_add_u32 m0, s41, 4096
  s_waitcnt vmcnt(27)
  buffer_load_dwordx4 v1, s[28:31], s40 offen offset:0 nt lds
  ds_read_b32 v6, v3 offset:16
  s_waitcnt vmcnt(27)
  buffer_load_dwordx4 v1, s[28:31], s40 offen offset:1024 nt lds
  s_waitcnt vmcnt(27)
  buffer_load_dwordx4 v1, s[28:31], s40 offen offset:2048 nt lds
  s_waitcnt vmcnt(27)
  buffer_load_dwordx4 v1, s[28:31], s40 offen offset:3072 nt lds
  v_add_u32 v5, -3, v7
  ds_write_b32 v3, v5
  s_add_u32 s40, s40, 4096
  s_add_u32 s41, s41, 8192
  s_cmp_eq_u32 s41, 147456
  s_cselect_b32 s41, 0, s41
  s_waitcnt lgkmcnt(1)
  v_readfirstlane_b32 s45, v6
  s_sub_i32 s45, s45, -3
  s_cmp_ge_i32 s45, s44
  s_cbranch_scc0 L_lslow28_2
L_lfree28_2:
  s_mov_b32 m0, s41
  s_waitcnt vmcnt(27)
  buffer_load_dwordx4 v1, s[28:31], s40 offen offset:0 nt lds
  s_waitcnt vmcnt(27)
  buffer_load_dwordx4 v1, s[28:31], s40 offen offset:1024 nt lds
  s_waitcnt vmcnt(27)
  buffer_load_dwordx4 v1, s[28:31], s40 offen offset:2048 nt lds
  s_waitcnt vmcnt(27)
  buffer_load_dwordx4 v1, s[28:31], s40 offen offset:3072 nt lds
  v_add_u32 v5, -2, v7
  ds_write_b32 v3, v5
  s_add_u32 s40, s40, 4096
  s_add_u32 m0, s41, 4096
  s_waitcnt vmcnt(27)
  buffer_load_dwordx4 v1, s[28:31], s40 offen offset:0 nt lds
  ds_read_b32 v6, v3 offset:20
  s_waitcnt vmcnt(27)
  buffer_load_dwordx4 v1, s[28:31], s40 offen offset:1024 nt lds
  s_waitcnt vmcnt(27)
  buffer_load_dwordx4 v1, s[28:31], s40 offen offset:2048 nt lds
  s_waitcnt vmcnt(27)
  buffer_load_dwordx4 v1, s[28:31], s40 offen offset:3072 nt lds
  v_add_u32 v5, -1, v7
  ds_write_b32 v3, v5
  s_add_u32 s40, s40, 4096
  s_add_u32 s41, s41, 8192
  s_cmp_eq_u32 s41, 147456
  s_cselect_b32 s41, 0, s41
  s_waitcnt lgkmcnt(1)
  v_readfirstlane_b32 s45, v6
  s_sub_i32 s45, s45, -3
  s_cmp_ge_i32 s45, s44
  s_cbranch_scc0 L_lslow28_3
L_lfree28_3:
  s_mov_b32 m0, s41
  s_waitcnt vmcnt(27)
  buffer_load_dwordx4 v1, s[28:31], s40 offen offset:0 nt lds
  s_waitcnt vmcnt(27)
  buffer_load_dwordx4 v1, s[28:31], s40 offen offset:1024 nt lds
  s_waitcnt vmcnt(27)
  buffer_load_dwordx4 v1, s[28:31], s40 offen offset:2048 nt lds
  s_waitcnt vmcnt(27)
  buffer_load_dwordx4 v1, s[28:31], s40 offen offset:3072 nt lds
  v_add_u32 v5, 0, v7
  ds_write_b32 v3, v5
  s_add_u32 s40, s40, 4096
  s_add_u32 m0, s41, 4096
  s_waitcnt vmcnt(27)
  buffer_load_dwordx4 v1, s[28:31], s40 offen offset:0 nt lds
  ds_read_b32 v6, v3 offset:24
  ds_read_b32 v8, v3 offset:12
  s_waitcnt vmcnt(27)
  buffer_load_dwordx4 v1, s[28:31], s40 offen offset:1024 nt lds
  s_waitcnt vmcnt(27)
  buffer_load_dwordx4 v1, s[28:31], s40 offen offset:2048 nt lds
  s_waitcnt vmcnt(27)
  buffer_load_dwordx4 v1, s[28:31], s40 offen offset:3072 nt lds
  v_add_u32 v5, 1, v7
  ds_write_b32 v3, v5
  s_add_u32 s40, s40, 4096
  s_add_u32 s41, s41, 8192
  s_cmp_eq_u32 s41, 147456
  s_cselect_b32 s41, 0, s41
  s_branch L_disp
L_lslow_0:
  s_sleep 1
  ds_read_b32 v6, v3 offset:24
  s_waitcnt lgkmcnt(0)
  v_readfirstlane_b32 s45, v6
  s_sub_i32 s45, s45, -4
  s_cmp_ge_i32 s45, s44
  s_cbranch_scc0 L_lslow_0
  s_branch L_lfree_0
L_lslow13_1:
  s_sleep 1
  ds_read_b32 v6, v3 offset:28
  s_waitcnt lgkmcnt(0)
  v_readfirstlane_b32 s45, v6
  s_sub_i32 s45, s45, -4
  s_cmp_ge_i32 s45, s44
  s_cbranch_scc0 L_lslow13_1
  s_branch L_lfree13_1
L_lslow13_2:
  s_sleep 1
  ds_read_b32 v6, v3 offset:16
  s_waitcnt lgkmcnt(0)
  v_readfirstlane_b32 s45, v6
  s_sub_i32 s45, s45, -3
  s_cmp_ge_i32 s45, s44
  s_cbranch_scc0 L_lslow13_2
  s_branch L_lfree13_2
L_lslow13_3:
  s_sleep 1
  ds_read_b32 v6, v3 offset:20
  s_waitcnt lgkmcnt(0)
  v_readfirstlane_b32 s45, v6
  s_sub_i32 s45, s45, -3
  s_cmp_ge_i32 s45, s44
  s_cbranch_scc0 L_lslow13_3
  s_branch L_lfree13_3
L_lslow16_1:
  s_sleep 1
  ds_read_b32 v6, v3 offset:28
  s_waitcnt lgkmcnt(0)
  v_readfirstlane_b32 s45, v6
  s_sub_i32 s45, s45, -4
  s_cmp_ge_i32 s45, s44
  s_cbranch_scc0 L_lslow16_1
  s_branch L_lfree16_1
L_lslow16_2:
  s_sleep 1
  ds_read_b32 v6, v3 offset:16
  s_waitcnt lgkmcnt(0)
  v_readfirstlane_b32 s45, v6
  s_sub_i32 s45, s45, -3
  s_cmp_ge_i32 s45, s44
  s_cbranch_scc0 L_lslow16_2
  s_branch L_lfree16_2
L_lslow16_3:
  s_sleep 1
  ds_read_b32 v6, v3 offset:20
  s_waitcnt lgkmcnt(0)
  v_readfirstlane_b32 s45, v6
  s_sub_i32 s45, s45, -3
  s_cmp_ge_i32 s45, s44
  s_cbranch_scc0 L_lslow16_3
  s_branch L_lfree16_3
L_lslow19_1:
  s_sleep 1
  ds_read_b32 v6, v3 offset:28
  s_waitcnt lgkmcnt(0)
  v_readfirstlane_b32 s45, v6
  s_sub_i32 s45, s45, -4
  s_cmp_ge_i32 s45, s44
  s_cbranch_scc0 L_lslow19_1
  s_branch L_lfree19_1
L_lslow19_2:
  s_sleep 1
  ds_read_b32 v6, v3 offset:16
  s_waitcnt lgkmcnt(0)
  v_readfirstlane_b32 s45, v6
  s_sub_i32 s45, s45, -3
  s_cmp_ge_i32 s45, s44
  s_cbranch_scc0 L_lslow19_2
  s_branch L_lfree19_2
L_lslow19_3:
  s_sleep 1
  ds_read_b32 v6, v3 offset:20
  s_waitcnt lgkmcnt(0)
  v_readfirstlane_b32 s45, v6
  s_sub_i32 s45, s45, -3
  s_cmp_ge_i32 s45, s44
  s_cbranch_scc0 L_lslow19_3
  s_branch L_lfree19_3
L_lslow22_1:
  s_sleep 1
  ds_read_b32 v6, v3 offset:28
  s_waitcnt lgkmcnt(0)
  v_readfirstlane_b32 s45, v6
  s_sub_i32 s45, s45, -4
  s_cmp_ge_i32 s45, s44
  s_cbranch_scc0 L_lslow22_1
  s_branch L_lfree22_1
L_lslow22_2:
  s_sleep 1
  ds_read_b32 v6, v3 offset:16
  s_waitcnt lgkmcnt(0)
  v_readfirstlane_b32 s45, v6
  s_sub_i32 s45, s45, -3
  s_cmp_ge_i32 s45, s44
  s_cbranch_scc0 L_lslow22_2
  s_branch L_lfree22_2
L_lslow22_3:
  s_sleep 1
  ds_read_b32 v6, v3 offset:20
  s_waitcnt lgkmcnt(0)
  v_readfirstlane_b32 s45, v6
  s_sub_i32 s45, s45, -3
  s_cmp_ge_i32 s45, s44
  s_cbranch_scc0 L_lslow22_3
  s_branch L_lfree22_3
L_lslow25_1:
  s_sleep 1
  ds_read_b32 v6, v3 offset:28
  s_waitcnt lgkmcnt(0)
  v_readfirstlane_b32 s45, v6
  s_sub_i32 s45, s45, -4
  s_cmp_ge_i32 s45, s44
  s_cbranch_scc0 L_lslow25_1
  s_branch L_lfree25_1
L_lslow25_2:
  s_sleep 1
  ds_read_b32 v6, v3 offset:16
  s_waitcnt lgkmcnt(0)
  v_readfirstlane_b32 s45, v6
  s_sub_i32 s45, s45, -3
  s_cmp_ge_i32 s45, s44
  s_cbranch_scc0 L_lslow25_2
  s_branch L_lfree25_2
L_lslow25_3:
  s_sleep 1
  ds_read_b32 v6, v3 offset:20
  s_waitcnt lgkmcnt(0)
  v_readfirstlane_b32 s45, v6
  s_sub_i32 s45, s45, -3
  s_cmp_ge_i32 s45, s44
  s_cbranch_scc0 L_lslow25_3
  s_branch L_lfree25_3
L_lslow28_1:
  s_sleep 1
  ds_read_b32 v6, v3 offset:28
  s_waitcnt lgkmcnt(0)
  v_readfirstlane_b32 s45, v6
  s_sub_i32 s45, s45, -4
  s_cmp_ge_i32 s45, s44
  s_cbranch_scc0 L_lslow28_1
  s_branch L_lfree28_1
L_lslow28_2:
  s_sleep 1
  ds_read_b32 v6, v3 offset:16
  s_waitcnt lgkmcnt(0)
  v_readfirstlane_b32 s45, v6
  s_sub_i32 s45, s45, -3
  s_cmp_ge_i32 s45, s44
  s_cbranch_scc0 L_lslow28_2
  s_branch L_lfree28_2
L_lslow28_3:
  s_sleep 1
  ds_read_b32 v6, v3 offset:20
  s_waitcnt lgkmcnt(0)
  v_readfirstlane_b32 s45, v6
  s_sub_i32 s45, s45, -3
  s_cmp_ge_i32 s45, s44
  s_cbranch_scc0 L_lslow28_3
  s_branch L_lfree28_3
L_drain:
  v_add_u32 v5, -6, v7
  s_waitcnt vmcnt(24)
  ds_write_b32 v3, v5
  v_add_u32 v5, -5, v7
  s_waitcnt vmcnt(20)
  ds_write_b32 v3, v5
  v_add_u32 v5, -4, v7
  s_waitcnt vmcnt(16)
  ds_write_b32 v3, v5
  v_add_u32 v5, -3, v7
  s_waitcnt vmcnt(12)
  ds_write_b32 v3, v5
  v_add_u32 v5, -2, v7
  s_waitcnt vmcnt(8)
  ds_write_b32 v3, v5
  v_add_u32 v5, -1, v7
  s_waitcnt vmcnt(4)
  ds_write_b32 v3, v5
  v_add_u32 v5, 0, v7
  s_waitcnt vmcnt(0)
  ds_write_b32 v3, v5
  s_endpgm
L_notloader:
  v_lshrrev_b32 v3, 4, v2
  v_and_b32 v4, 15, v2
  s_mov_b32 s43, 0xffff0000
  s_mov_b32 s42, 0x3fb8aa3b
  s_lshl_b32 s39, s37, 10
  s_mov_b32 s30, 1024
  s_mov_b32 s31, 0x20000
  s_mov_b32 s35, 0x20000
  s_cmp_ge_u32 s3, 5
  s_cbranch_scc1 L_helper
  s_sub_u32 s3, s3, 1
  s_lshl_b32 s38, s3, 20
  s_lshl_b32 s46, s36, 8
  s_add_u32 s38, s38, s46
  v_lshlrev_b32 v5, 18, v3
  v_lshl_add_u32 v5, v4, 4, v5
  v_add_u32 v5, s38, v5
  s_mov_b32 s34, 0x400000
  s_lshl_b32 s40, s37, 15
  s_waitcnt lgkmcnt(0)
  s_add_u32 s28, s4, s39
  s_addc_u32 s29, s5, 0
  s_mov_b32 s32, s10
  s_mov_b32 s33, s11
  buffer_load_dwordx4 v[8:11], v1, s[28:31], 0 offen
  buffer_load_dwordx4 v[40:43], v5, s[32:35], s40 offen
  s_add_u32 s40, s40, 8192
  buffer_load_dwordx4 v[44:47], v5, s[32:35], s40 offen
  s_add_u32 s40, s40, 8192
  buffer_load_dwordx4 v[48:51], v5, s[32:35], s40 offen
  s_add_u32 s40, s40, 8192
  buffer_load_dwordx4 v[52:55], v5, s[32:35], s40 offen
  s_add_u32 s40, s40, 8192
  s_and_b32 s40, s40, 262143
  buffer_load_dwordx4 v[56:59], v5, s[32:35], s40 offen
  s_add_u32 s40, s40, 8192
  buffer_load_dwordx4 v[60:63], v5, s[32:35], s40 offen
  s_add_u32 s40, s40, 8192
  buffer_load_dwordx4 v[64:67], v5, s[32:35], s40 offen
  s_add_u32 s40, s40, 8192
  buffer_load_dwordx4 v[68:71], v5, s[32:35], s40 offen
  s_add_u32 s40, s40, 8192
  s_and_b32 s40, s40, 262143
  buffer_load_dwordx4 v[72:75], v5, s[32:35], s40 offen
  s_add_u32 s40, s40, 8192
  buffer_load_dwordx4 v[76:79], v5, s[32:35], s40 offen
  s_add_u32 s40, s40, 8192
  buffer_load_dwordx4 v[80:83], v5, s[32:35], s40 offen
  s_add_u32 s40, s40, 8192
  buffer_load_dwordx4 v[84:87], v5, s[32:35], s40 offen
  s_add_u32 s40, s40, 8192
  s_and_b32 s40, s40, 262143
  s_barrier
  s_waitcnt vmcnt(12)
  v_lshlrev_b32 v12, 16, v8
  v_and_b32 v13, s43, v8
  v_lshlrev_b32 v14, 16, v9
  v_and_b32 v15, s43, v9
  v_lshlrev_b32 v16, 16, v10
  v_and_b32 v17, s43, v10
  v_lshlrev_b32 v18, 16, v11
  v_and_b32 v19, s43, v11
  v_add_f32 v20, v12, v13
  v_add_f32 v21, v14, v15
  v_add_f32 v22, v16, v17
  v_add_f32 v23, v18, v19
  v_add_f32 v20, v20, v21
  v_add_f32 v22, v22, v23
  v_add_f32 v20, v20, v22
  s_nop 1
  v_add_f32_dpp v20, v20, v20 row_ror:8 row_mask:0xf bank_mask:0xf
  s_nop 1
  v_add_f32_dpp v20, v20, v20 row_ror:4 row_mask:0xf bank_mask:0xf
  s_nop 1
  v_add_f32_dpp v20, v20, v20 row_ror:2 row_mask:0xf bank_mask:0xf
  s_nop 1
  v_add_f32_dpp v20, v20, v20 row_ror:1 row_mask:0xf bank_mask:0xf
  v_mov_b32 v21, v20
  s_nop 1
  v_permlane16_swap_b32 v20, v21
  v_add_f32 v20, v20, v21
  v_mov_b32 v21, v20
  s_nop 1
  v_permlane32_swap_b32 v20, v21
  v_add_f32 v20, v20, v21
  s_waitcnt vmcnt(5)
  buffer_load_dwordx4 v[88:91], v5, s[32:35], s40 offen
  s_add_u32 s40, s40, 8192
  v_mul_f32 v20, 0x3b000000, v20
  v_mov_b32 v22, 0
  v_sub_f32 v21, v12, v20
  v_fmac_f32 v22, v21, v21
  v_sub_f32 v21, v13, v20
  v_fmac_f32 v22, v21, v21
  v_sub_f32 v21, v14, v20
  v_fmac_f32 v22, v21, v21
  v_sub_f32 v21, v15, v20
  v_fmac_f32 v22, v21, v21
  v_sub_f32 v21, v16, v20
  v_fmac_f32 v22, v21, v21
  v_sub_f32 v21, v17, v20
  v_fmac_f32 v22, v21, v21
  v_sub_f32 v21, v18, v20
  v_fmac_f32 v22, v21, v21
  v_sub_f32 v21, v19, v20
  v_fmac_f32 v22, v21, v21
  s_waitcnt vmcnt(5)
  buffer_load_dwordx4 v[92:95], v5, s[32:35], s40 offen
  s_add_u32 s40, s40, 8192
  s_nop 1
  v_add_f32_dpp v22, v22, v22 row_ror:8 row_mask:0xf bank_mask:0xf
  s_nop 1
  v_add_f32_dpp v22, v22, v22 row_ror:4 row_mask:0xf bank_mask:0xf
  s_nop 1
  v_add_f32_dpp v22, v22, v22 row_ror:2 row_mask:0xf bank_mask:0xf
  s_nop 1
  v_add_f32_dpp v22, v22, v22 row_ror:1 row_mask:0xf bank_mask:0xf
  v_mov_b32 v21, v22
  s_nop 1
  v_permlane16_swap_b32 v22, v21
  v_add_f32 v22, v22, v21
  v_mov_b32 v21, v22
  s_nop 1
  v_permlane32_swap_b32 v22, v21
  v_add_f32 v22, v22, v21
  s_waitcnt vmcnt(5)
  buffer_load_dwordx4 v[96:99], v5, s[32:35], s40 offen
  s_add_u32 s40, s40, 8192
  v_mul_f32 v22, 0x3b000000, v22
  v_cvt_pk_bf16_f32 v20, v20, v22
  v_and_b32 v22, s43, v20
  v_lshlrev_b32 v20, 16, v20
  v_add_f32 v22, 0x3727c5ac, v22
  v_cvt_pk_bf16_f32 v22, v22, v22
  v_and_b32 v22, s43, v22
  v_sqrt_f32 v22, v22
  s_nop 0
  v_cvt_pk_bf16_f32 v22, v22, v22
  v_and_b32 v22, s43, v22
  v_rcp_f32 v22, v22
  s_waitcnt vmcnt(5)
  buffer_load_dwordx4 v[100:103], v5, s[32:35], s40 offen
  s_add_u32 s40, s40, 8192
  s_and_b32 s40, s40, 262143
  v_sub_f32 v12, v12, v20
  v_sub_f32 v13, v13, v20
  v_sub_f32 v14, v14, v20
  v_sub_f32 v15, v15, v20
  v_sub_f32 v16, v16, v20
  v_sub_f32 v17, v17, v20
  v_sub_f32 v18, v18, v20
  v_sub_f32 v19, v19, v20
  v_cvt_pk_bf16_f32 v8, v12, v13
  v_cvt_pk_bf16_f32 v9, v14, v15
  v_cvt_pk_bf16_f32 v10, v16, v17
  v_cvt_pk_bf16_f32 v11, v18, v19
  v_lshlrev_b32 v12, 16, v8
  v_and_b32 v13, s43, v8
  v_lshlrev_b32 v14, 16, v9
  v_and_b32 v15, s43, v9
  v_lshlrev_b32 v16, 16, v10
  v_and_b32 v17, s43, v10
  v_lshlrev_b32 v18, 16, v11
  v_and_b32 v19, s43, v11
  v_mul_f32 v12, v22, v12
  v_mul_f32 v13, v22, v13
  v_mul_f32 v14, v22, v14
  v_mul_f32 v15, v22, v15
  v_mul_f32 v16, v22, v16
  v_mul_f32 v17, v22, v17
  v_mul_f32 v18, v22, v18
  v_mul_f32 v19, v22, v19
  v_cvt_pk_bf16_f32 v8, v12, v13
  v_cvt_pk_bf16_f32 v9, v14, v15
  v_cvt_pk_bf16_f32 v10, v16, v17
  v_cvt_pk_bf16_f32 v11, v18, v19
  s_mov_b32 s45, 147456
  v_add_u32 v6, s45, v1
  ds_write_b128 v6, v[8:11]
  s_waitcnt vmcnt(5)
  buffer_load_dwordx4 v[104:107], v5, s[32:35], s40 offen
  s_add_u32 s40, s40, 8192
  s_lshl_b32 s46, s3, 8
  s_add_u32 s46, s46, s45
  v_lshlrev_b32 v7, 6, v3
  v_add_u32 v7, s46, v7
  s_waitcnt lgkmcnt(0)
  s_add_u32 s46, s37, 0
  s_and_b32 s46, s46, 7
  s_lshl_b32 s46, s46, 3
  v_add_u32 v12, s46, v7
  ds_read_b64 v[16:17], v12
  s_add_u32 s46, s37, 1
  s_and_b32 s46, s46, 7
  s_lshl_b32 s46, s46, 3
  v_add_u32 v12, s46, v7
  ds_read_b64 v[18:19], v12
  s_add_u32 s46, s37, 2
  s_and_b32 s46, s46, 7
  s_lshl_b32 s46, s46, 3
  v_add_u32 v12, s46, v7
  ds_read_b64 v[20:21], v12
  s_add_u32 s46, s37, 3
  s_and_b32 s46, s46, 7
  s_lshl_b32 s46, s46, 3
  v_add_u32 v12, s46, v7
  ds_read_b64 v[22:23], v12
  s_add_u32 s46, s37, 4
  s_and_b32 s46, s46, 7
  s_lshl_b32 s46, s46, 3
  v_add_u32 v12, s46, v7
  ds_read_b64 v[24:25], v12
  s_add_u32 s46, s37, 5
  s_and_b32 s46, s46, 7
  s_lshl_b32 s46, s46, 3
  v_add_u32 v12, s46, v7
  ds_read_b64 v[26:27], v12
  s_add_u32 s46, s37, 6
  s_and_b32 s46, s46, 7
  s_lshl_b32 s46, s46, 3
  v_add_u32 v12, s46, v7
  ds_read_b64 v[28:29], v12
  s_add_u32 s46, s37, 7
  s_and_b32 s46, s46, 7
  s_lshl_b32 s46, s46, 3
  v_add_u32 v12, s46, v7
  ds_read_b64 v[30:31], v12
  v_mov_b32 v32, 0
  v_mov_b32 v33, 0
  v_mov_b32 v34, 0
  v_mov_b32 v35, 0
  v_mov_b32 v36, 0
  v_mov_b32 v37, 0
  v_mov_b32 v38, 0
  v_mov_b32 v39, 0
  s_waitcnt lgkmcnt(0)
  v_and_b32 v12, 0xffff, v16
  v_lshlrev_b32 v13, 16, v16
  s_waitcnt vmcnt(5)
  buffer_load_dwordx4 v[108:111], v5, s[32:35], s40 offen
  s_add_u32 s40, s40, 8192
  v_dot2c_f32_bf16 v32, v40, v12
  v_dot2c_f32_bf16 v33, v40, v13
  v_dot2c_f32_bf16 v34, v41, v12
  v_dot2c_f32_bf16 v35, v41, v13
  v_dot2c_f32_bf16 v36, v42, v12
  v_dot2c_f32_bf16 v37, v42, v13
  v_dot2c_f32_bf16 v38, v43, v12
  v_dot2c_f32_bf16 v39, v43, v13
  v_lshrrev_b32 v12, 16, v16
  v_and_b32 v13, s43, v16
  s_waitcnt vmcnt(5)
  buffer_load_dwordx4 v[112:115], v5, s[32:35], s40 offen
  s_add_u32 s40, s40, 8192
  v_dot2c_f32_bf16 v32, v44, v12
  v_dot2c_f32_bf16 v33, v44, v13
  v_dot2c_f32_bf16 v34, v45, v12
  v_dot2c_f32_bf16 v35, v45, v13
  v_dot2c_f32_bf16 v36, v46, v12
  v_dot2c_f32_bf16 v37, v46, v13
  v_dot2c_f32_bf16 v38, v47, v12
  v_dot2c_f32_bf16 v39, v47, v13
  v_and_b32 v12, 0xffff, v17
  v_lshlrev_b32 v13, 16, v17
  s_waitcnt vmcnt(5)
  buffer_load_dwordx4 v[116:119], v5, s[32:35], s40 offen
  s_add_u32 s40, s40, 8192
  s_and_b32 s40, s40, 262143
  v_dot2c_f32_bf16 v32, v48, v12
  v_dot2c_f32_bf16 v33, v48, v13
  v_dot2c_f32_bf16 v34, v49, v12
  v_dot2c_f32_bf16 v35, v49, v13
  v_dot2c_f32_bf16 v36, v50, v12
  v_dot2c_f32_bf16 v37, v50, v13
  v_dot2c_f32_bf16 v38, v51, v12
  v_dot2c_f32_bf16 v39, v51, v13
  v_lshrrev_b32 v12, 16, v17
  v_and_b32 v13, s43, v17
  s_waitcnt vmcnt(5)
  buffer_load_dwordx4 v[120:123], v5, s[32:35], s40 offen
  s_add_u32 s40, s40, 8192
  v_dot2c_f32_bf16 v32, v52, v12
  v_dot2c_f32_bf16 v33, v52, v13
  v_dot2c_f32_bf16 v34, v53, v12
  v_dot2c_f32_bf16 v35, v53, v13
  v_dot2c_f32_bf16 v36, v54, v12
  v_dot2c_f32_bf16 v37, v54, v13
  v_dot2c_f32_bf16 v38, v55, v12
  v_dot2c_f32_bf16 v39, v55, v13
  v_and_b32 v12, 0xffff, v18
  v_lshlrev_b32 v13, 16, v18
  s_waitcnt vmcnt(5)
  buffer_load_dwordx4 v[124:127], v5, s[32:35], s40 offen
  s_add_u32 s40, s40, 8192
  v_dot2c_f32_bf16 v32, v56, v12
  v_dot2c_f32_bf16 v33, v56, v13
  v_dot2c_f32_bf16 v34, v57, v12
  v_dot2c_f32_bf16 v35, v57, v13
  v_dot2c_f32_bf16 v36, v58, v12
  v_dot2c_f32_bf16 v37, v58, v13
  v_dot2c_f32_bf16 v38, v59, v12
  v_dot2c_f32_bf16 v39, v59, v13
  v_lshrrev_b32 v12, 16, v18
  v_and_b32 v13, s43, v18
  s_waitcnt vmcnt(5)
  buffer_load_dwordx4 v[128:131], v5, s[32:35], s40 offen
  s_add_u32 s40, s40, 8192
  v_dot2c_f32_bf16 v32, v60, v12
  v_dot2c_f32_bf16 v33, v60, v13
  v_dot2c_f32_bf16 v34, v61, v12
  v_dot2c_f32_bf16 v35, v61, v13
  v_dot2c_f32_bf16 v36, v62, v12
  v_dot2c_f32_bf16 v37, v62, v13
  v_dot2c_f32_bf16 v38, v63, v12
  v_dot2c_f32_bf16 v39, v63, v13
  v_and_b32 v12, 0xffff, v19
  v_lshlrev_b32 v13, 16, v19
  s_waitcnt vmcnt(5)
  buffer_load_dwordx4 v[132:135], v5, s[32:35], s40 offen
  s_add_u32 s40, s40, 8192
  s_and_b32 s40, s40, 262143
  v_dot2c_f32_bf16 v32, v64, v12
  v_dot2c_f32_bf16 v33, v64, v13
  v_dot2c_f32_bf16 v34, v65, v12
  v_dot2c_f32_bf16 v35, v65, v13
  v_dot2c_f32_bf16 v36, v66, v12
  v_dot2c_f32_bf16 v37, v66, v13
  v_dot2c_f32_bf16 v38, v67, v12
  v_dot2c_f32_bf16 v39, v67, v13
  v_lshrrev_b32 v12, 16, v19
  v_and_b32 v13, s43, v19
  s_waitcnt vmcnt(5)
  buffer_load_dwordx4 v[136:139], v5, s[32:35], s40 offen
  s_add_u32 s40, s40, 8192
  v_dot2c_f32_bf16 v32, v68, v12
  v_dot2c_f32_bf16 v33, v68, v13
  v_dot2c_f32_bf16 v34, v69, v12
  v_dot2c_f32_bf16 v35, v69, v13
  v_dot2c_f32_bf16 v36, v70, v12
  v_dot2c_f32_bf16 v37, v70, v13
  v_dot2c_f32_bf16 v38, v71, v12
  v_dot2c_f32_bf16 v39, v71, v13
  v_and_b32 v12, 0xffff, v20
  v_lshlrev_b32 v13, 16, v20
  s_waitcnt vmcnt(5)
  buffer_load_dwordx4 v[140:143], v5, s[32:35], s40 offen
  s_add_u32 s40, s40, 8192
  v_dot2c_f32_bf16 v32, v72, v12
  v_dot2c_f32_bf16 v33, v72, v13
  v_dot2c_f32_bf16 v34, v73, v12
  v_dot2c_f32_bf16 v35, v73, v13
  v_dot2c_f32_bf16 v36, v74, v12
  v_dot2c_f32_bf16 v37, v74, v13
  v_dot2c_f32_bf16 v38, v75, v12
  v_dot2c_f32_bf16 v39, v75, v13
  v_lshrrev_b32 v12, 16, v20
  v_and_b32 v13, s43, v20
  s_waitcnt vmcnt(5)
  buffer_load_dwordx4 v[144:147], v5, s[32:35], s40 offen
  s_add_u32 s40, s40, 8192
  v_dot2c_f32_bf16 v32, v76, v12
  v_dot2c_f32_bf16 v33, v76, v13
  v_dot2c_f32_bf16 v34, v77, v12
  v_dot2c_f32_bf16 v35, v77, v13
  v_dot2c_f32_bf16 v36, v78, v12
  v_dot2c_f32_bf16 v37, v78, v13
  v_dot2c_f32_bf16 v38, v79, v12
  v_dot2c_f32_bf16 v39, v79, v13
  v_and_b32 v12, 0xffff, v21
  v_lshlrev_b32 v13, 16, v21
  s_waitcnt vmcnt(5)
  buffer_load_dwordx4 v[148:151], v5, s[32:35], s40 offen
  s_add_u32 s40, s40, 8192
  s_and_b32 s40, s40, 262143
  v_dot2c_f32_bf16 v32, v80, v12
  v_dot2c_f32_bf16 v33, v80, v13
  v_dot2c_f32_bf16 v34, v81, v12
  v_dot2c_f32_bf16 v35, v81, v13
  v_dot2c_f32_bf16 v36, v82, v12
  v_dot2c_f32_bf16 v37, v82, v13
  v_dot2c_f32_bf16 v38, v83, v12
  v_dot2c_f32_bf16 v39, v83, v13
  v_lshrrev_b32 v12, 16, v21
  v_and_b32 v13, s43, v21
  s_waitcnt vmcnt(5)
  buffer_load_dwordx4 v[152:155], v5, s[32:35], s40 offen
  s_add_u32 s40, s40, 8192
  v_dot2c_f32_bf16 v32, v84, v12
  v_dot2c_f32_bf16 v33, v84, v13
  v_dot2c_f32_bf16 v34, v85, v12
  v_dot2c_f32_bf16 v35, v85, v13
  v_dot2c_f32_bf16 v36, v86, v12
  v_dot2c_f32_bf16 v37, v86, v13
  v_dot2c_f32_bf16 v38, v87, v12
  v_dot2c_f32_bf16 v39, v87, v13
  v_and_b32 v12, 0xffff, v22
  v_lshlrev_b32 v13, 16, v22
  s_waitcnt vmcnt(5)
  buffer_load_dwordx4 v[156:159], v5, s[32:35], s40 offen
  s_add_u32 s40, s40, 8192
  v_dot2c_f32_bf16 v32, v88, v12
  v_dot2c_f32_bf16 v33, v88, v13
  v_dot2c_f32_bf16 v34, v89, v12
  v_dot2c_f32_bf16 v35, v89, v13
  v_dot2c_f32_bf16 v36, v90, v12
  v_dot2c_f32_bf16 v37, v90, v13
  v_dot2c_f32_bf16 v38, v91, v12
  v_dot2c_f32_bf16 v39, v91, v13
  v_lshrrev_b32 v12, 16, v22
  v_and_b32 v13, s43, v22
  s_waitcnt vmcnt(5)
  buffer_load_dwordx4 v[160:163], v5, s[32:35], s40 offen
  s_add_u32 s40, s40, 8192
  v_dot2c_f32_bf16 v32, v92, v12
  v_dot2c_f32_bf16 v33, v92, v13
  v_dot2c_f32_bf16 v34, v93, v12
  v_dot2c_f32_bf16 v35, v93, v13
  v_dot2c_f32_bf16 v36, v94, v12
  v_dot2c_f32_bf16 v37, v94, v13
  v_dot2c_f32_bf16 v38, v95, v12
  v_dot2c_f32_bf16 v39, v95, v13
  v_and_b32 v12, 0xffff, v23
  v_lshlrev_b32 v13, 16, v23
  s_waitcnt vmcnt(5)
  buffer_load_dwordx4 v[164:167], v5, s[32:35], s40 offen
  s_add_u32 s40, s40, 8192
  s_and_b32 s40, s40, 262143
  v_dot2c_f32_bf16 v32, v96, v12
  v_dot2c_f32_bf16 v33, v96, v13
  v_dot2c_f32_bf16 v34, v97, v12
  v_dot2c_f32_bf16 v35, v97, v13
  v_dot2c_f32_bf16 v36, v98, v12
  v_dot2c_f32_bf16 v37, v98, v13
  v_dot2c_f32_bf16 v38, v99, v12
  v_dot2c_f32_bf16 v39, v99, v13
  v_lshrrev_b32 v12, 16, v23
  v_and_b32 v13, s43, v23
  s_waitcnt vmcnt(16)
  v_dot2c_f32_bf16 v32, v100, v12
  v_dot2c_f32_bf16 v33, v100, v13
  v_dot2c_f32_bf16 v34, v101, v12
  v_dot2c_f32_bf16 v35, v101, v13
  v_dot2c_f32_bf16 v36, v102, v12
  v_dot2c_f32_bf16 v37, v102, v13
  v_dot2c_f32_bf16 v38, v103, v12
  v_dot2c_f32_bf16 v39, v103, v13
  v_and_b32 v12, 0xffff, v24
  v_lshlrev_b32 v13, 16, v24
  s_waitcnt vmcnt(15)
  v_dot2c_f32_bf16 v32, v104, v12
  v_dot2c_f32_bf16 v33, v104, v13
  v_dot2c_f32_bf16 v34, v105, v12
  v_dot2c_f32_bf16 v35, v105, v13
  v_dot2c_f32_bf16 v36, v106, v12
  v_dot2c_f32_bf16 v37, v106, v13
  v_dot2c_f32_bf16 v38, v107, v12
  v_dot2c_f32_bf16 v39, v107, v13
  v_lshrrev_b32 v12, 16, v24
  v_and_b32 v13, s43, v24
  s_waitcnt vmcnt(14)
  v_dot2c_f32_bf16 v32, v108, v12
  v_dot2c_f32_bf16 v33, v108, v13
  v_dot2c_f32_bf16 v34, v109, v12
  v_dot2c_f32_bf16 v35, v109, v13
  v_dot2c_f32_bf16 v36, v110, v12
  v_dot2c_f32_bf16 v37, v110, v13
  v_dot2c_f32_bf16 v38, v111, v12
  v_dot2c_f32_bf16 v39, v111, v13
  v_and_b32 v12, 0xffff, v25
  v_lshlrev_b32 v13, 16, v25
  s_waitcnt vmcnt(13)
  v_dot2c_f32_bf16 v32, v112, v12
  v_dot2c_f32_bf16 v33, v112, v13
  v_dot2c_f32_bf16 v34, v113, v12
  v_dot2c_f32_bf16 v35, v113, v13
  v_dot2c_f32_bf16 v36, v114, v12
  v_dot2c_f32_bf16 v37, v114, v13
  v_dot2c_f32_bf16 v38, v115, v12
  v_dot2c_f32_bf16 v39, v115, v13
  v_lshrrev_b32 v12, 16, v25
  v_and_b32 v13, s43, v25
  s_waitcnt vmcnt(12)
  v_dot2c_f32_bf16 v32, v116, v12
  v_dot2c_f32_bf16 v33, v116, v13
  v_dot2c_f32_bf16 v34, v117, v12
  v_dot2c_f32_bf16 v35, v117, v13
  v_dot2c_f32_bf16 v36, v118, v12
  v_dot2c_f32_bf16 v37, v118, v13
  v_dot2c_f32_bf16 v38, v119, v12
  v_dot2c_f32_bf16 v39, v119, v13
  v_and_b32 v12, 0xffff, v26
  v_lshlrev_b32 v13, 16, v26
  s_waitcnt vmcnt(11)
  v_dot2c_f32_bf16 v32, v120, v12
  v_dot2c_f32_bf16 v33, v120, v13
  v_dot2c_f32_bf16 v34, v121, v12
  v_dot2c_f32_bf16 v35, v121, v13
  v_dot2c_f32_bf16 v36, v122, v12
  v_dot2c_f32_bf16 v37, v122, v13
  v_dot2c_f32_bf16 v38, v123, v12
  v_dot2c_f32_bf16 v39, v123, v13
  v_lshrrev_b32 v12, 16, v26
  v_and_b32 v13, s43, v26
  s_waitcnt vmcnt(10)
  v_dot2c_f32_bf16 v32, v124, v12
  v_dot2c_f32_bf16 v33, v124, v13
  v_dot2c_f32_bf16 v34, v125, v12
  v_dot2c_f32_bf16 v35, v125, v13
  v_dot2c_f32_bf16 v36, v126, v12
  v_dot2c_f32_bf16 v37, v126, v13
  v_dot2c_f32_bf16 v38, v127, v12
  v_dot2c_f32_bf16 v39, v127, v13
  v_and_b32 v12, 0xffff, v27
  v_lshlrev_b32 v13, 16, v27
  s_waitcnt vmcnt(9)
  v_dot2c_f32_bf16 v32, v128, v12
  v_dot2c_f32_bf16 v33, v128, v13
  v_dot2c_f32_bf16 v34, v129, v12
  v_dot2c_f32_bf16 v35, v129, v13
  v_dot2c_f32_bf16 v36, v130, v12
  v_dot2c_f32_bf16 v37, v130, v13
  v_dot2c_f32_bf16 v38, v131, v12
  v_dot2c_f32_bf16 v39, v131, v13
  v_lshrrev_b32 v12, 16, v27
  v_and_b32 v13, s43, v27
  s_waitcnt vmcnt(8)
  v_dot2c_f32_bf16 v32, v132, v12
  v_dot2c_f32_bf16 v33, v132, v13
  v_dot2c_f32_bf16 v34, v133, v12
  v_dot2c_f32_bf16 v35, v133, v13
  v_dot2c_f32_bf16 v36, v134, v12
  v_dot2c_f32_bf16 v37, v134, v13
  v_dot2c_f32_bf16 v38, v135, v12
  v_dot2c_f32_bf16 v39, v135, v13
  v_and_b32 v12, 0xffff, v28
  v_lshlrev_b32 v13, 16, v28
  s_waitcnt vmcnt(7)
  v_dot2c_f32_bf16 v32, v136, v12
  v_dot2c_f32_bf16 v33, v136, v13
  v_dot2c_f32_bf16 v34, v137, v12
  v_dot2c_f32_bf16 v35, v137, v13
  v_dot2c_f32_bf16 v36, v138, v12
  v_dot2c_f32_bf16 v37, v138, v13
  v_dot2c_f32_bf16 v38, v139, v12
  v_dot2c_f32_bf16 v39, v139, v13
  v_lshrrev_b32 v12, 16, v28
  v_and_b32 v13, s43, v28
  s_waitcnt vmcnt(6)
  v_dot2c_f32_bf16 v32, v140, v12
  v_dot2c_f32_bf16 v33, v140, v13
  v_dot2c_f32_bf16 v34, v141, v12
  v_dot2c_f32_bf16 v35, v141, v13
  v_dot2c_f32_bf16 v36, v142, v12
  v_dot2c_f32_bf16 v37, v142, v13
  v_dot2c_f32_bf16 v38, v143, v12
  v_dot2c_f32_bf16 v39, v143, v13
  v_and_b32 v12, 0xffff, v29
  v_lshlrev_b32 v13, 16, v29
  s_waitcnt vmcnt(5)
  v_dot2c_f32_bf16 v32, v144, v12
  v_dot2c_f32_bf16 v33, v144, v13
  v_dot2c_f32_bf16 v34, v145, v12
  v_dot2c_f32_bf16 v35, v145, v13
  v_dot2c_f32_bf16 v36, v146, v12
  v_dot2c_f32_bf16 v37, v146, v13
  v_dot2c_f32_bf16 v38, v147, v12
  v_dot2c_f32_bf16 v39, v147, v13
  v_lshrrev_b32 v12, 16, v29
  v_and_b32 v13, s43, v29
  s_waitcnt vmcnt(4)
  v_dot2c_f32_bf16 v32, v148, v12
  v_dot2c_f32_bf16 v33, v148, v13
  v_dot2c_f32_bf16 v34, v149, v12
  v_dot2c_f32_bf16 v35, v149, v13
  v_dot2c_f32_bf16 v36, v150, v12
  v_dot2c_f32_bf16 v37, v150, v13
  v_dot2c_f32_bf16 v38, v151, v12
  v_dot2c_f32_bf16 v39, v151, v13
  v_and_b32 v12, 0xffff, v30
  v_lshlrev_b32 v13, 16, v30
  s_waitcnt vmcnt(3)
  v_dot2c_f32_bf16 v32, v152, v12
  v_dot2c_f32_bf16 v33, v152, v13
  v_dot2c_f32_bf16 v34, v153, v12
  v_dot2c_f32_bf16 v35, v153, v13
  v_dot2c_f32_bf16 v36, v154, v12
  v_dot2c_f32_bf16 v37, v154, v13
  v_dot2c_f32_bf16 v38, v155, v12
  v_dot2c_f32_bf16 v39, v155, v13
  v_lshrrev_b32 v12, 16, v30
  v_and_b32 v13, s43, v30
  s_waitcnt vmcnt(2)
  v_dot2c_f32_bf16 v32, v156, v12
  v_dot2c_f32_bf16 v33, v156, v13
  v_dot2c_f32_bf16 v34, v157, v12
  v_dot2c_f32_bf16 v35, v157, v13
  v_dot2c_f32_bf16 v36, v158, v12
  v_dot2c_f32_bf16 v37, v158, v13
  v_dot2c_f32_bf16 v38, v159, v12
  v_dot2c_f32_bf16 v39, v159, v13
  v_and_b32 v12, 0xffff, v31
  v_lshlrev_b32 v13, 16, v31
  s_waitcnt vmcnt(1)
  v_dot2c_f32_bf16 v32, v160, v12
  v_dot2c_f32_bf16 v33, v160, v13
  v_dot2c_f32_bf16 v34, v161, v12
  v_dot2c_f32_bf16 v35, v161, v13
  v_dot2c_f32_bf16 v36, v162, v12
  v_dot2c_f32_bf16 v37, v162, v13
  v_dot2c_f32_bf16 v38, v163, v12
  v_dot2c_f32_bf16 v39, v163, v13
  v_lshrrev_b32 v12, 16, v31
  v_and_b32 v13, s43, v31
  s_waitcnt vmcnt(0)
  v_dot2c_f32_bf16 v32, v164, v12
  v_dot2c_f32_bf16 v33, v164, v13
  v_dot2c_f32_bf16 v34, v165, v12
  v_dot2c_f32_bf16 v35, v165, v13
  v_dot2c_f32_bf16 v36, v166, v12
  v_dot2c_f32_bf16 v37, v166, v13
  v_dot2c_f32_bf16 v38, v167, v12
  v_dot2c_f32_bf16 v39, v167, v13
  v_lshlrev_b32 v7, 5, v4
  v_add_u32 v7, 147456, v7
  v_lshl_add_u32 v6, v3, 2, v7
  s_lshl_b32 s46, s3, 9
  v_add_u32 v6, s46, v6
  v_permlane16_swap_b32 v32, v33
  v_permlane16_swap_b32 v34, v35
  v_permlane16_swap_b32 v36, v37
  v_permlane16_swap_b32 v38, v39
  v_add_f32 v32, v32, v33
  v_add_f32 v34, v34, v35
  v_add_f32 v36, v36, v37
  v_add_f32 v38, v38, v39
  v_mov_b32 v39, 1
  v_permlane32_swap_b32 v32, v34
  v_permlane32_swap_b32 v36, v38
  v_add_f32 v32, v32, v34
  v_add_f32 v36, v36, v38
  ds_write_b32 v6, v32 offset:1024
  ds_write_b32 v6, v36 offset:1040
  v_mov_b32 v38, 150592
  s_waitcnt lgkmcnt(0)
  s_mov_b64 exec, 1
  ds_add_u32 v38, v39 offset:4
  s_mov_b64 exec, -1
L_qw:
  ds_read_b32 v39, v38 offset:4
  s_waitcnt lgkmcnt(0)
  v_readfirstlane_b32 s45, v39
  s_cmp_ge_u32 s45, 4
  s_cbranch_scc1 L_qw_ok
  s_sleep 1
  s_branch L_qw
L_qw_ok:
  ds_read_b128 v[40:43], v7 offset:1024
  ds_read_b128 v[44:47], v7 offset:1040
  ds_read_b128 v[48:51], v7 offset:1536
  ds_read_b128 v[52:55], v7 offset:1552
  ds_read_b128 v[56:59], v7 offset:2048
  ds_read_b128 v[60:63], v7 offset:2064
  ds_read_b128 v[64:67], v7 offset:2560
  ds_read_b128 v[68:71], v7 offset:2576
  s_mov_b32 s41, 0x3db504f3
  v_mov_b32 v16, 0xff800000
  s_lshl_b32 s44, s3, 13
  v_add_u32 v36, s44, v1
  s_lshl_b32 s46, s3, 2
  v_add_u32 v37, s46, v38
  s_lshl_b32 s47, s3, 1
  s_add_u32 s47, s47, 1
  v_mov_b32 v27, 0
  s_lshl_b32 s40, s3, 11
  s_add_u32 s40, s40, 152064
  v_lshlrev_b32 v17, 4, v3
  v_add_u32 v17, s40, v17
  v_and_b32 v5, 14, v4
  v_add_u32 v5, v5, v17
  v_and_b32 v26, 2, v2
  v_cmp_ne_u32 vcc, 0, v26
  s_waitcnt lgkmcnt(4)
  v_add_f32 v40, v40, v48
  v_add_f32 v41, v41, v49
  v_add_f32 v42, v42, v50
  v_add_f32 v43, v43, v51
  v_add_f32 v44, v44, v52
  v_add_f32 v45, v45, v53
  v_add_f32 v46, v46, v54
  v_add_f32 v47, v47, v55
  s_waitcnt lgkmcnt(0)
  v_add_f32 v56, v56, v64
  v_add_f32 v57, v57, v65
  v_add_f32 v58, v58, v66
  v_add_f32 v59, v59, v67
  v_add_f32 v60, v60, v68
  v_add_f32 v61, v61, v69
  v_add_f32 v62, v62, v70
  v_add_f32 v63, v63, v71
  v_add_f32 v40, v40, v56
  v_add_f32 v41, v41, v57
  v_add_f32 v42, v42, v58
  v_add_f32 v43, v43, v59
  v_add_f32 v44, v44, v60
  v_add_f32 v45, v45, v61
  v_add_f32 v46, v46, v62
  v_add_f32 v47, v47, v63
  v_cvt_pk_bf16_f32 v72, v40, v41
  v_cvt_pk_bf16_f32 v73, v42, v43
  v_cvt_pk_bf16_f32 v74, v44, v45
  v_cvt_pk_bf16_f32 v75, v46, v47
L_kloop:
L_pk:
  ds_read_b32 v39, v38 offset:0
  s_waitcnt lgkmcnt(0)
  v_readfirstlane_b32 s45, v39
  s_cmp_ge_u32 s45, s47
  s_cbranch_scc1 L_pk_ok
  s_sleep 1
  s_branch L_pk
L_pk_ok:
  ds_read_b128 v[40:43], v36 offset:0
  ds_read_b128 v[44:47], v36 offset:1024
  ds_read_b128 v[48:51], v36 offset:2048
  ds_read_b128 v[52:55], v36 offset:3072
  v_mov_b32 v18, 0
  v_mov_b32 v19, 0
  v_mov_b32 v20, 0
  v_mov_b32 v21, 0
  v_mov_b32 v22, 0
  v_mov_b32 v23, 0
  v_mov_b32 v24, 0
  v_mov_b32 v25, 0
  s_waitcnt lgkmcnt(3)
  v_dot2c_f32_bf16 v18, v40, v72
  v_dot2c_f32_bf16 v18, v41, v73
  v_dot2c_f32_bf16 v18, v42, v74
  v_dot2c_f32_bf16 v18, v43, v75
  s_waitcnt lgkmcnt(2)
  v_dot2c_f32_bf16 v19, v44, v72
  v_dot2c_f32_bf16 v19, v45, v73
  v_dot2c_f32_bf16 v19, v46, v74
  v_dot2c_f32_bf16 v19, v47, v75
  s_waitcnt lgkmcnt(1)
  v_dot2c_f32_bf16 v20, v48, v72
  v_dot2c_f32_bf16 v20, v49, v73
  v_dot2c_f32_bf16 v20, v50, v74
  v_dot2c_f32_bf16 v20, v51, v75
  s_waitcnt lgkmcnt(0)
  v_dot2c_f32_bf16 v21, v52, v72
  v_dot2c_f32_bf16 v21, v53, v73
  v_dot2c_f32_bf16 v21, v54, v74
  v_dot2c_f32_bf16 v21, v55, v75
  s_cmp_gt_u32 s45, s47
  s_cbranch_scc1 L_pk2_ok
  s_add_u32 s46, s47, 1
L_pk2:
  ds_read_b32 v39, v38 offset:0
  s_waitcnt lgkmcnt(0)
  v_readfirstlane_b32 s45, v39
  s_cmp_ge_u32 s45, s46
  s_cbranch_scc1 L_pk2_ok
  s_sleep 1
  s_branch L_pk2
L_pk2_ok:
  ds_read_b128 v[56:59], v36 offset:4096
  ds_read_b128 v[60:63], v36 offset:5120
  ds_read_b128 v[64:67], v36 offset:6144
  ds_read_b128 v[68:71], v36 offset:7168
  v_add_u32 v27, 1, v27
  s_add_u32 s44, s44, 0x8000
  s_sub_u32 s46, s44, 147456
  s_cselect_b32 s44, s44, s46
  v_add_u32 v36, s44, v1
  s_add_u32 s47, s47, 8
  s_waitcnt lgkmcnt(3)
  v_dot2c_f32_bf16 v22, v56, v72
  v_dot2c_f32_bf16 v22, v57, v73
  v_dot2c_f32_bf16 v22, v58, v74
  v_dot2c_f32_bf16 v22, v59, v75
  s_waitcnt lgkmcnt(2)
  v_dot2c_f32_bf16 v23, v60, v72
  v_dot2c_f32_bf16 v23, v61, v73
  v_dot2c_f32_bf16 v23, v62, v74
  v_dot2c_f32_bf16 v23, v63, v75
  s_waitcnt lgkmcnt(1)
  v_dot2c_f32_bf16 v24, v64, v72
  v_dot2c_f32_bf16 v24, v65, v73
  v_dot2c_f32_bf16 v24, v66, v74
  v_dot2c_f32_bf16 v24, v67, v75
  s_waitcnt lgkmcnt(0)
  ds_write_b32 v37, v27 offset:16
  v_dot2c_f32_bf16 v25, v68, v72
  v_dot2c_f32_bf16 v25, v69, v73
  v_dot2c_f32_bf16 v25, v70, v74
  v_dot2c_f32_bf16 v25, v71, v75
  v_add_f32_dpp v18, v18, v18 row_ror:8 row_mask:0xf bank_mask:0x3
  v_add_f32_dpp v19, v19, v19 row_ror:8 row_mask:0xf bank_mask:0x3
  v_add_f32_dpp v20, v20, v20 row_ror:8 row_mask:0xf bank_mask:0x3
  v_add_f32_dpp v21, v21, v21 row_ror:8 row_mask:0xf bank_mask:0x3
  v_add_f32_dpp v18, v22, v22 row_ror:8 row_mask:0xf bank_mask:0xc
  v_add_f32_dpp v19, v23, v23 row_ror:8 row_mask:0xf bank_mask:0xc
  v_add_f32_dpp v20, v24, v24 row_ror:8 row_mask:0xf bank_mask:0xc
  v_add_f32_dpp v21, v25, v25 row_ror:8 row_mask:0xf bank_mask:0xc
  v_add_f32_dpp v18, v18, v18 row_ror:12 row_mask:0xf bank_mask:0x5
  v_add_f32_dpp v19, v19, v19 row_ror:12 row_mask:0xf bank_mask:0x5
  s_nop 0
  v_add_f32_dpp v18, v20, v20 row_ror:4 row_mask:0xf bank_mask:0xa
  v_add_f32_dpp v19, v21, v21 row_ror:4 row_mask:0xf bank_mask:0xa
  s_nop 0
  v_add_f32_dpp v18, v18, v18 quad_perm:[2,3,0,1] row_mask:0xf bank_mask:0xf
  v_add_f32_dpp v19, v19, v19 quad_perm:[2,3,0,1] row_mask:0xf bank_mask:0xf
  v_cndmask_b32 v20, v18, v19, vcc
  s_nop 1
  v_add_f32_dpp v20, v20, v20 quad_perm:[1,0,3,2] row_mask:0xf bank_mask:0xf
  v_cvt_pk_bf16_f32 v20, 0, v20
  v_mul_f32 v20, s41, v20
  v_cvt_pk_bf16_f32 v20, v20, v20
  ds_write_b16 v5, v20
  v_and_b32 v21, s43, v20
  v_max_f32 v16, v16, v21
  v_add_u32 v5, 64, v5
  s_cmp_lt_u32 s47, 256
  s_cbranch_scc1 L_kloop
  v_lshlrev_b32 v5, 1, v1
  v_add_u32 v5, s40, v5
  s_waitcnt lgkmcnt(0)
  ds_read_b128 v[40:43], v5
  ds_read_b128 v[44:47], v5 offset:16
  v_max_f32_dpp v16, v16, v16 row_ror:8 row_mask:0xf bank_mask:0xf
  s_nop 1
  v_max_f32_dpp v16, v16, v16 row_ror:4 row_mask:0xf bank_mask:0xf
  s_nop 1
  v_max_f32_dpp v16, v16, v16 row_ror:2 row_mask:0xf bank_mask:0xf
  s_nop 1
  v_max_f32_dpp v16, v16, v16 row_ror:1 row_mask:0xf bank_mask:0xf
  s_nop 1
  v_mov_b32 v18, v16
  s_nop 1
  v_permlane16_swap_b32 v16, v18
  v_max_f32 v16, v16, v18
  v_mov_b32 v18, v16
  s_nop 1
  v_permlane32_swap_b32 v16, v18
  v_max_f32 v16, v16, v18
  v_mul_f32 v18, s42, v16
  s_waitcnt lgkmcnt(0)
  v_lshlrev_b32 v48, 16, v40
  v_and_b32 v49, s43, v40
  v_lshlrev_b32 v50, 16, v41
  v_and_b32 v51, s43, v41
  v_lshlrev_b32 v52, 16, v42
  v_and_b32 v53, s43, v42
  v_lshlrev_b32 v54, 16, v43
  v_and_b32 v55, s43, v43
  v_lshlrev_b32 v56, 16, v44
  v_and_b32 v57, s43, v44
  v_lshlrev_b32 v58, 16, v45
  v_and_b32 v59, s43, v45
  v_lshlrev_b32 v60, 16, v46
  v_and_b32 v61, s43, v46
  v_lshlrev_b32 v62, 16, v47
  v_and_b32 v63, s43, v47
  v_fma_f32 v48, v48, s42, -v18
  v_fma_f32 v49, v49, s42, -v18
  v_fma_f32 v50, v50, s42, -v18
  v_fma_f32 v51, v51, s42, -v18
  v_fma_f32 v52, v52, s42, -v18
  v_fma_f32 v53, v53, s42, -v18
  v_fma_f32 v54, v54, s42, -v18
  v_fma_f32 v55, v55, s42, -v18
  v_fma_f32 v56, v56, s42, -v18
  v_fma_f32 v57, v57, s42, -v18
  v_fma_f32 v58, v58, s42, -v18
  v_fma_f32 v59, v59, s42, -v18
  v_fma_f32 v60, v60, s42, -v18
  v_fma_f32 v61, v61, s42, -v18
  v_fma_f32 v62, v62, s42, -v18
  v_fma_f32 v63, v63, s42, -v18
  v_exp_f32 v48, v48
  v_exp_f32 v49, v49
  v_exp_f32 v50, v50
  v_exp_f32 v51, v51
  v_exp_f32 v52, v52
  v_exp_f32 v53, v53
  v_exp_f32 v54, v54
  v_exp_f32 v55, v55
  v_exp_f32 v56, v56
  v_exp_f32 v57, v57
  v_exp_f32 v58, v58
  v_exp_f32 v59, v59
  v_exp_f32 v60, v60
  v_exp_f32 v61, v61
  v_exp_f32 v62, v62
  v_exp_f32 v63, v63
  v_add_f32 v19, v48, v49
  v_add_f32 v20, v50, v51
  v_add_f32 v19, v19, v52
  v_add_f32 v20, v20, v53
  v_add_f32 v19, v19, v54
  v_add_f32 v20, v20, v55
  v_add_f32 v19, v19, v56
  v_add_f32 v20, v20, v57
  v_add_f32 v19, v19, v58
  v_add_f32 v20, v20, v59
  v_add_f32 v19, v19, v60
  v_add_f32 v20, v20, v61
  v_add_f32 v19, v19, v62
  v_add_f32 v20, v20, v63
  v_add_f32 v19, v19, v20
  s_nop 1
  v_add_f32_dpp v19, v19, v19 row_ror:8 row_mask:0xf bank_mask:0xf
  s_nop 1
  v_add_f32_dpp v19, v19, v19 row_ror:4 row_mask:0xf bank_mask:0xf
  s_nop 1
  v_add_f32_dpp v19, v19, v19 row_ror:2 row_mask:0xf bank_mask:0xf
  s_nop 1
  v_add_f32_dpp v19, v19, v19 row_ror:1 row_mask:0xf bank_mask:0xf
  v_mov_b32 v20, v19
  s_nop 1
  v_permlane16_swap_b32 v19, v20
  v_add_f32 v19, v19, v20
  v_mov_b32 v20, v19
  s_nop 1
  v_permlane32_swap_b32 v19, v20
  v_add_f32 v19, v19, v20
  v_subrev_u32 v21, 64, v37
  ds_write_b32 v21, v16
  ds_write_b32 v21, v19 offset:16
  v_mov_b32 v39, 1
  s_waitcnt lgkmcnt(0)
  s_mov_b64 exec, 1
  ds_add_u32 v38, v39 offset:8
  s_mov_b64 exec, -1
L_mw:
  ds_read_b32 v39, v38 offset:8
  s_waitcnt lgkmcnt(0)
  v_readfirstlane_b32 s45, v39
  s_cmp_ge_u32 s45, 4
  s_cbranch_scc1 L_mw_ok
  s_sleep 1
  s_branch L_mw
L_mw_ok:
  v_subrev_u32 v21, 64, v38
  ds_read_b128 v[8:11], v21
  ds_read_b128 v[12:15], v21 offset:16
  s_waitcnt lgkmcnt(1)
  v_max3_f32 v20, v8, v9, v10
  v_max_f32 v20, v20, v11
  v_sub_f32 v8, v8, v20
  v_sub_f32 v9, v9, v20
  v_sub_f32 v10, v10, v20
  v_sub_f32 v11, v11, v20
  v_sub_f32 v16, v16, v20
  v_mul_f32 v8, s42, v8
  v_mul_f32 v9, s42, v9
  v_mul_f32 v10, s42, v10
  v_mul_f32 v11, s42, v11
  v_mul_f32 v16, s42, v16
  v_exp_f32 v8, v8
  v_exp_f32 v9, v9
  v_exp_f32 v10, v10
  v_exp_f32 v11, v11
  v_exp_f32 v16, v16
  s_waitcnt lgkmcnt(0)
  v_mul_f32 v20, v8, v12
  v_fmac_f32 v20, v9, v13
  v_fmac_f32 v20, v10, v14
  v_fmac_f32 v20, v11, v15
  v_rcp_f32 v20, v20
  s_nop 0
  v_mul_f32 v16, v16, v20
  v_mul_f32 v48, v16, v48
  v_mul_f32 v49, v16, v49
  v_mul_f32 v50, v16, v50
  v_mul_f32 v51, v16, v51
  v_mul_f32 v52, v16, v52
  v_mul_f32 v53, v16, v53
  v_mul_f32 v54, v16, v54
  v_mul_f32 v55, v16, v55
  v_mul_f32 v56, v16, v56
  v_mul_f32 v57, v16, v57
  v_mul_f32 v58, v16, v58
  v_mul_f32 v59, v16, v59
  v_mul_f32 v60, v16, v60
  v_mul_f32 v61, v16, v61
  v_mul_f32 v62, v16, v62
  v_mul_f32 v63, v16, v63
  v_cvt_pk_bf16_f32 v40, v48, v49
  v_cvt_pk_bf16_f32 v41, v50, v51
  v_cvt_pk_bf16_f32 v42, v52, v53
  v_cvt_pk_bf16_f32 v43, v54, v55
  v_cvt_pk_bf16_f32 v44, v56, v57
  v_cvt_pk_bf16_f32 v45, v58, v59
  v_cvt_pk_bf16_f32 v46, v60, v61
  v_cvt_pk_bf16_f32 v47, v62, v63
  ds_write_b128 v5, v[40:43]
  ds_write_b128 v5, v[44:47] offset:16
  v_mov_b32 v8, 0
  v_mov_b32 v9, 0
  v_mov_b32 v10, 0
  v_mov_b32 v11, 0
  v_mov_b32 v12, 0
  v_mov_b32 v13, 0
  v_mov_b32 v14, 0
  v_mov_b32 v15, 0
  s_waitcnt lgkmcnt(0)
L_vloop:
  ds_read_b128 v[28:31], v17
  v_add_u32 v17, 64, v17
L_pv:
  ds_read_b32 v39, v38 offset:0
  s_waitcnt lgkmcnt(0)
  v_readfirstlane_b32 s45, v39
  s_cmp_ge_u32 s45, s47
  s_cbranch_scc1 L_pv_ok
  s_sleep 1
  s_branch L_pv
L_pv_ok:
  ds_read_b128 v[40:43], v36 offset:0
  ds_read_b128 v[44:47], v36 offset:1024
  ds_read_b128 v[48:51], v36 offset:2048
  ds_read_b128 v[52:55], v36 offset:3072
  v_and_b32 v76, 0xffff, v28
  v_lshlrev_b32 v77, 16, v28
  v_lshrrev_b32 v78, 16, v28
  v_and_b32 v79, s43, v28
  v_and_b32 v80, 0xffff, v29
  v_lshlrev_b32 v81, 16, v29
  v_lshrrev_b32 v82, 16, v29
  v_and_b32 v83, s43, v29
  v_and_b32 v84, 0xffff, v30
  v_lshlrev_b32 v85, 16, v30
  v_lshrrev_b32 v86, 16, v30
  v_and_b32 v87, s43, v30
  v_and_b32 v88, 0xffff, v31
  v_lshlrev_b32 v89, 16, v31
  v_lshrrev_b32 v90, 16, v31
  v_and_b32 v91, s43, v31
  s_waitcnt lgkmcnt(3)
  v_dot2c_f32_bf16 v8, v40, v76
  v_dot2c_f32_bf16 v9, v40, v77
  v_dot2c_f32_bf16 v10, v41, v76
  v_dot2c_f32_bf16 v11, v41, v77
  v_dot2c_f32_bf16 v12, v42, v76
  v_dot2c_f32_bf16 v13, v42, v77
  v_dot2c_f32_bf16 v14, v43, v76
  v_dot2c_f32_bf16 v15, v43, v77
  s_waitcnt lgkmcnt(2)
  v_dot2c_f32_bf16 v8, v44, v78
  v_dot2c_f32_bf16 v9, v44, v79
  v_dot2c_f32_bf16 v10, v45, v78
  v_dot2c_f32_bf16 v11, v45, v79
  v_dot2c_f32_bf16 v12, v46, v78
  v_dot2c_f32_bf16 v13, v46, v79
  v_dot2c_f32_bf16 v14, v47, v78
  v_dot2c_f32_bf16 v15, v47, v79
  s_waitcnt lgkmcnt(1)
  v_dot2c_f32_bf16 v8, v48, v80
  v_dot2c_f32_bf16 v9, v48, v81
  v_dot2c_f32_bf16 v10, v49, v80
  v_dot2c_f32_bf16 v11, v49, v81
  v_dot2c_f32_bf16 v12, v50, v80
  v_dot2c_f32_bf16 v13, v50, v81
  v_dot2c_f32_bf16 v14, v51, v80
  v_dot2c_f32_bf16 v15, v51, v81
  s_waitcnt lgkmcnt(0)
  v_dot2c_f32_bf16 v8, v52, v82
  v_dot2c_f32_bf16 v9, v52, v83
  v_dot2c_f32_bf16 v10, v53, v82
  v_dot2c_f32_bf16 v11, v53, v83
  v_dot2c_f32_bf16 v12, v54, v82
  v_dot2c_f32_bf16 v13, v54, v83
  v_dot2c_f32_bf16 v14, v55, v82
  v_dot2c_f32_bf16 v15, v55, v83
  s_cmp_gt_u32 s45, s47
  s_cbranch_scc1 L_pv2_ok
  s_add_u32 s46, s47, 1
L_pv2:
  ds_read_b32 v39, v38 offset:0
  s_waitcnt lgkmcnt(0)
  v_readfirstlane_b32 s45, v39
  s_cmp_ge_u32 s45, s46
  s_cbranch_scc1 L_pv2_ok
  s_sleep 1
  s_branch L_pv2
L_pv2_ok:
  ds_read_b128 v[56:59], v36 offset:4096
  ds_read_b128 v[60:63], v36 offset:5120
  ds_read_b128 v[64:67], v36 offset:6144
  ds_read_b128 v[68:71], v36 offset:7168
  v_add_u32 v27, 1, v27
  s_add_u32 s44, s44, 0x8000
  s_sub_u32 s46, s44, 147456
  s_cselect_b32 s44, s44, s46
  v_add_u32 v36, s44, v1
  s_add_u32 s47, s47, 8
  s_waitcnt lgkmcnt(3)
  v_dot2c_f32_bf16 v8, v56, v84
  v_dot2c_f32_bf16 v9, v56, v85
  v_dot2c_f32_bf16 v10, v57, v84
  v_dot2c_f32_bf16 v11, v57, v85
  v_dot2c_f32_bf16 v12, v58, v84
  v_dot2c_f32_bf16 v13, v58, v85
  v_dot2c_f32_bf16 v14, v59, v84
  v_dot2c_f32_bf16 v15, v59, v85
  s_waitcnt lgkmcnt(2)
  v_dot2c_f32_bf16 v8, v60, v86
  v_dot2c_f32_bf16 v9, v60, v87
  v_dot2c_f32_bf16 v10, v61, v86
  v_dot2c_f32_bf16 v11, v61, v87
  v_dot2c_f32_bf16 v12, v62, v86
  v_dot2c_f32_bf16 v13, v62, v87
  v_dot2c_f32_bf16 v14, v63, v86
  v_dot2c_f32_bf16 v15, v63, v87
  s_waitcnt lgkmcnt(1)
  v_dot2c_f32_bf16 v8, v64, v88
  v_dot2c_f32_bf16 v9, v64, v89
  v_dot2c_f32_bf16 v10, v65, v88
  v_dot2c_f32_bf16 v11, v65, v89
  v_dot2c_f32_bf16 v12, v66, v88
  v_dot2c_f32_bf16 v13, v66, v89
  v_dot2c_f32_bf16 v14, v67, v88
  v_dot2c_f32_bf16 v15, v67, v89
  s_waitcnt lgkmcnt(0)
  ds_write_b32 v37, v27 offset:16
  v_dot2c_f32_bf16 v8, v68, v90
  v_dot2c_f32_bf16 v9, v68, v91
  v_dot2c_f32_bf16 v10, v69, v90
  v_dot2c_f32_bf16 v11, v69, v91
  v_dot2c_f32_bf16 v12, v70, v90
  v_dot2c_f32_bf16 v13, v70, v91
  v_dot2c_f32_bf16 v14, v71, v90
  v_dot2c_f32_bf16 v15, v71, v91
  s_cmp_lt_u32 s47, 512
  s_cbranch_scc1 L_vloop
  s_nop 1
  v_permlane16_swap_b32 v8, v9
  v_permlane16_swap_b32 v10, v11
  v_permlane16_swap_b32 v12, v13
  v_permlane16_swap_b32 v14, v15
  v_add_f32 v8, v8, v9
  v_add_f32 v10, v10, v11
  v_add_f32 v12, v12, v13
  v_add_f32 v14, v14, v15
  s_nop 0
  v_permlane32_swap_b32 v8, v10
  v_permlane32_swap_b32 v12, v14
  v_add_f32 v8, v8, v10
  v_add_f32 v12, v12, v14
  ds_write_b32 v6, v8 offset:1024
  ds_write_b32 v6, v12 offset:1040
  s_waitcnt lgkmcnt(0)
  s_barrier
  s_endpgm
L_helper:
  s_sub_u32 s3, s3, 5
  s_cmp_lg_u32 s3, 2
  s_cbranch_scc1 L_nopf
  s_getpc_b64 s[46:47]
L_pc:
  s_sub_u32 s46, s46, L_pc-recurrent_scan__mha_block_cached__geglu_ffn__decode_kernel
  s_subb_u32 s47, s47, 0
  s_lshr_b32 s45, s2, 3
  s_min_u32 s45, s45, (L_end-recurrent_scan__mha_block_cached__geglu_ffn__decode_kernel)/1024-1
  s_lshl_b32 s45, s45, 10
  v_add_u32 v6, s45, v1
  global_load_dwordx4 v[8:11], v6, s[46:47]
L_nopf:
  s_load_dwordx2 s[12:13], s[0:1], 32
  s_load_dwordx8 s[16:23], s[0:1], 48
  s_load_dwordx4 s[24:27], s[0:1], 80
  v_mov_b32 v38, 150592
  s_barrier
  s_waitcnt lgkmcnt(0)
  s_lshl_b32 s38, s37, 16
  s_add_u32 s48, s26, s38
  s_addc_u32 s49, s27, 0
  s_mov_b32 s50, 0x10000
  s_mov_b32 s51, 0x20000
  s_cmp_ge_u32 s3, 4
  s_cbranch_scc1 L_notwo
  v_lshlrev_b32 v34, 5, v4
  v_lshrrev_b32 v7, 1, v3
  v_lshl_add_u32 v34, v7, 4, v34
  s_lshl_b32 s14, s3, 9
  s_lshl_b32 s46, s36, 11
  s_add_u32 s14, s14, s46
  s_mov_b32 s32, s12
  s_mov_b32 s33, s13
  s_mov_b32 s34, 0x400000
  s_lshl_b32 s46, s36, 17
  s_lshl_b32 s47, s3, 8
  s_add_u32 s46, s46, s47
  v_lshlrev_b32 v5, 15, v3
  v_lshl_add_u32 v5, v4, 4, v5
  v_add_u32 v5, s46, v5
  s_mov_b32 s40, 0
  s_mov_b32 s46, 0x05040100
  s_mov_b32 s47, 0x07060302
  s_cmp_eq_u32 s3, 1
  s_cselect_b32 s28, s18, s16
  s_cselect_b32 s29, s19, s17
  s_cmp_eq_u32 s3, 2
  s_cselect_b32 s28, s20, s28
  s_cselect_b32 s29, s21, s29
  s_cmp_eq_u32 s3, 3
  s_cselect_b32 s30, 0, 0x1c0000
  s_mov_b32 s41, 0
  s_lshl_b32 s45, s3, 12
  s_lshl_b32 s44, s36, 17
  s_lshl_b32 s15, s37, 14
  s_add_u32 s15, s15, s44
  s_add_u32 s15, s15, s45
  s_lshl_b32 s44, s36, 16
  s_lshl_b32 s45, s37, 13
  s_add_u32 s44, s44, s45
  s_cmp_eq_u32 s3, 2
  s_cselect_b32 s41, s44, s41
  v_lshrrev_b32 v6, 5, v2
  v_mul_u32_u24 v6, 3584, v6
  v_and_b32 v7, 0x1f0, v1
  v_add_u32 v6, v6, v7
  s_and_b32 s44, s2, 7
  s_lshr_b32 s45, s2, 3
  s_mul_i32 s45, s45, 57344
  s_lshl_b32 s13, s44, 9
  s_add_u32 s45, s45, s13
  s_cmp_eq_u32 s44, 7
  s_cselect_b32 s44, 0, s30
  s_cmp_lt_u32 s3, 2
  s_cselect_b32 s30, s44, s30
  s_cselect_b32 s41, s45, s41
  s_cselect_b64 vcc, -1, 0
  s_mov_b32 s13, 1024
  s_cselect_b32 s13, 7168, s13
  v_cndmask_b32 v6, v1, v6, vcc
  buffer_load_dwordx4 v[40:43], v6, s[28:31], s41 offen
  s_add_u32 s41, s41, s13
  buffer_load_dwordx4 v[44:47], v6, s[28:31], s41 offen
  s_add_u32 s41, s41, s13
  buffer_load_dwordx4 v[48:51], v6, s[28:31], s41 offen
  s_add_u32 s41, s41, s13
  buffer_load_dwordx4 v[52:55], v6, s[28:31], s41 offen
  s_add_u32 s41, s41, s13
  s_waitcnt vmcnt(3)
  buffer_load_dwordx4 v[56:59], v6, s[28:31], s41 offen
  s_add_u32 s41, s41, s13
  s_waitcnt vmcnt(3)
  buffer_load_dwordx4 v[60:63], v6, s[28:31], s41 offen
  s_add_u32 s41, s41, s13
  s_waitcnt vmcnt(3)
  buffer_load_dwordx4 v[64:67], v6, s[28:31], s41 offen
  s_add_u32 s41, s41, s13
  s_waitcnt vmcnt(3)
  buffer_load_dwordx4 v[68:71], v6, s[28:31], s41 offen
  s_add_u32 s41, s41, s13
  s_waitcnt vmcnt(3)
  buffer_load_dwordx4 v[72:75], v1, s[32:35], s15 offen offset:0
  s_waitcnt vmcnt(3)
  buffer_load_dwordx4 v[76:79], v1, s[32:35], s15 offen offset:1024
  s_waitcnt vmcnt(3)
  buffer_load_dwordx4 v[80:83], v1, s[32:35], s15 offen offset:2048
  s_waitcnt vmcnt(3)
  buffer_load_dwordx4 v[84:87], v1, s[32:35], s15 offen offset:3072
  s_mul_i32 s44, s3, 90
  s_add_u32 s44, s44, 80
L_wos:
  ds_read_b32 v39, v38 offset:0
  s_waitcnt lgkmcnt(0)
  v_readfirstlane_b32 s45, v39
  s_cmp_ge_u32 s45, s44
  s_cbranch_scc1 L_wos_ok
  s_sleep 32
  s_branch L_wos
L_wos_ok:
  buffer_load_dwordx4 v[8:11], v34, s[48:51], s14 offen sc1
  s_waitcnt vmcnt(0)
  v_and_b32 v35, 1, v8
  v_and_b32 v20, 1, v9
  v_lshl_or_b32 v35, v20, 1, v35
  v_and_b32 v20, 1, v10
  v_lshl_or_b32 v35, v20, 2, v35
  v_and_b32 v20, 1, v11
  v_lshl_or_b32 v35, v20, 3, v35
  v_xor_b32 v35, 15, v35
  buffer_load_dwordx4 v[40:43], v5, s[32:35], s40 offen offset:0
  buffer_load_dwordx4 v[44:47], v5, s[32:35], s40 offen offset:1024
  s_waitcnt vmcnt(1)
  buffer_load_dwordx4 v[48:51], v5, s[32:35], s40 offen offset:2048
  s_waitcnt vmcnt(1)
  buffer_load_dwordx4 v[52:55], v5, s[32:35], s40 offen offset:3072
  s_add_u32 s40, s40, 4096
  v_perm_b32 v12, v44, v40, s46
  v_perm_b32 v44, v44, v40, s47
  v_mov_b32 v40, v12
  v_perm_b32 v12, v45, v41, s46
  v_perm_b32 v45, v45, v41, s47
  v_mov_b32 v41, v12
  v_perm_b32 v12, v46, v42, s46
  v_perm_b32 v46, v46, v42, s47
  v_mov_b32 v42, v12
  v_perm_b32 v12, v47, v43, s46
  v_perm_b32 v47, v47, v43, s47
  v_mov_b32 v43, v12
  s_waitcnt vmcnt(1)
  buffer_load_dwordx4 v[56:59], v5, s[32:35], s40 offen offset:0
  s_waitcnt vmcnt(1)
  buffer_load_dwordx4 v[60:63], v5, s[32:35], s40 offen offset:1024
  v_perm_b32 v12, v52, v48, s46
  v_perm_b32 v52, v52, v48, s47
  v_mov_b32 v48, v12
  v_perm_b32 v12, v53, v49, s46
  v_perm_b32 v53, v53, v49, s47
  v_mov_b32 v49, v12
  v_perm_b32 v12, v54, v50, s46
  v_perm_b32 v54, v54, v50, s47
  v_mov_b32 v50, v12
  v_perm_b32 v12, v55, v51, s46
  v_perm_b32 v55, v55, v51, s47
  v_mov_b32 v51, v12
  s_waitcnt vmcnt(1)
  buffer_load_dwordx4 v[64:67], v5, s[32:35], s40 offen offset:2048
  s_waitcnt vmcnt(1)
  buffer_load_dwordx4 v[68:71], v5, s[32:35], s40 offen offset:3072
  s_add_u32 s40, s40, 4096
  v_perm_b32 v12, v60, v56, s46
  v_perm_b32 v60, v60, v56, s47
  v_mov_b32 v56, v12
  v_perm_b32 v12, v61, v57, s46
  v_perm_b32 v61, v61, v57, s47
  v_mov_b32 v57, v12
  v_perm_b32 v12, v62, v58, s46
  v_perm_b32 v62, v62, v58, s47
  v_mov_b32 v58, v12
  v_perm_b32 v12, v63, v59, s46
  v_perm_b32 v63, v63, v59, s47
  v_mov_b32 v59, v12
  s_waitcnt vmcnt(1)
  buffer_load_dwordx4 v[72:75], v5, s[32:35], s40 offen offset:0
  s_waitcnt vmcnt(1)
  buffer_load_dwordx4 v[76:79], v5, s[32:35], s40 offen offset:1024
  v_perm_b32 v12, v68, v64, s46
  v_perm_b32 v68, v68, v64, s47
  v_mov_b32 v64, v12
  v_perm_b32 v12, v69, v65, s46
  v_perm_b32 v69, v69, v65, s47
  v_mov_b32 v65, v12
  v_perm_b32 v12, v70, v66, s46
  v_perm_b32 v70, v70, v66, s47
  v_mov_b32 v66, v12
  v_perm_b32 v12, v71, v67, s46
  v_perm_b32 v71, v71, v67, s47
  v_mov_b32 v67, v12
  s_waitcnt vmcnt(1)
  buffer_load_dwordx4 v[80:83], v5, s[32:35], s40 offen offset:2048
  s_waitcnt vmcnt(1)
  buffer_load_dwordx4 v[84:87], v5, s[32:35], s40 offen offset:3072
  s_add_u32 s40, s40, 4096
  v_perm_b32 v12, v76, v72, s46
  v_perm_b32 v76, v76, v72, s47
  v_mov_b32 v72, v12
  v_perm_b32 v12, v77, v73, s46
  v_perm_b32 v77, v77, v73, s47
  v_mov_b32 v73, v12
  v_perm_b32 v12, v78, v74, s46
  v_perm_b32 v78, v78, v74, s47
  v_mov_b32 v74, v12
  v_perm_b32 v12, v79, v75, s46
  v_perm_b32 v79, v79, v75, s47
  v_mov_b32 v75, v12
  s_waitcnt vmcnt(1)
  buffer_load_dwordx4 v[88:91], v5, s[32:35], s40 offen offset:0
  s_waitcnt vmcnt(1)
  buffer_load_dwordx4 v[92:95], v5, s[32:35], s40 offen offset:1024
  v_perm_b32 v12, v84, v80, s46
  v_perm_b32 v84, v84, v80, s47
  v_mov_b32 v80, v12
  v_perm_b32 v12, v85, v81, s46
  v_perm_b32 v85, v85, v81, s47
  v_mov_b32 v81, v12
  v_perm_b32 v12, v86, v82, s46
  v_perm_b32 v86, v86, v82, s47
  v_mov_b32 v82, v12
  v_perm_b32 v12, v87, v83, s46
  v_perm_b32 v87, v87, v83, s47
  v_mov_b32 v83, v12
  s_waitcnt vmcnt(1)
  buffer_load_dwordx4 v[96:99], v5, s[32:35], s40 offen offset:2048
  s_waitcnt vmcnt(1)
  buffer_load_dwordx4 v[100:103], v5, s[32:35], s40 offen offset:3072
  s_add_u32 s40, s40, 4096
  v_perm_b32 v12, v92, v88, s46
  v_perm_b32 v92, v92, v88, s47
  v_mov_b32 v88, v12
  v_perm_b32 v12, v93, v89, s46
  v_perm_b32 v93, v93, v89, s47
  v_mov_b32 v89, v12
  v_perm_b32 v12, v94, v90, s46
  v_perm_b32 v94, v94, v90, s47
  v_mov_b32 v90, v12
  v_perm_b32 v12, v95, v91, s46
  v_perm_b32 v95, v95, v91, s47
  v_mov_b32 v91, v12
  s_waitcnt vmcnt(1)
  buffer_load_dwordx4 v[104:107], v5, s[32:35], s40 offen offset:0
  s_waitcnt vmcnt(1)
  buffer_load_dwordx4 v[108:111], v5, s[32:35], s40 offen offset:1024
  v_perm_b32 v12, v100, v96, s46
  v_perm_b32 v100, v100, v96, s47
  v_mov_b32 v96, v12
  v_perm_b32 v12, v101, v97, s46
  v_perm_b32 v101, v101, v97, s47
  v_mov_b32 v97, v12
  v_perm_b32 v12, v102, v98, s46
  v_perm_b32 v102, v102, v98, s47
  v_mov_b32 v98, v12
  v_perm_b32 v12, v103, v99, s46
  v_perm_b32 v103, v103, v99, s47
  v_mov_b32 v99, v12
  s_waitcnt vmcnt(1)
  buffer_load_dwordx4 v[112:115], v5, s[32:35], s40 offen offset:2048
  s_waitcnt vmcnt(1)
  buffer_load_dwordx4 v[116:119], v5, s[32:35], s40 offen offset:3072
  s_add_u32 s40, s40, 4096
  v_perm_b32 v12, v108, v104, s46
  v_perm_b32 v108, v108, v104, s47
  v_mov_b32 v104, v12
  v_perm_b32 v12, v109, v105, s46
  v_perm_b32 v109, v109, v105, s47
  v_mov_b32 v105, v12
  v_perm_b32 v12, v110, v106, s46
  v_perm_b32 v110, v110, v106, s47
  v_mov_b32 v106, v12
  v_perm_b32 v12, v111, v107, s46
  v_perm_b32 v111, v111, v107, s47
  v_mov_b32 v107, v12
  s_waitcnt vmcnt(1)
  buffer_load_dwordx4 v[120:123], v5, s[32:35], s40 offen offset:0
  s_waitcnt vmcnt(1)
  buffer_load_dwordx4 v[124:127], v5, s[32:35], s40 offen offset:1024
  v_perm_b32 v12, v116, v112, s46
  v_perm_b32 v116, v116, v112, s47
  v_mov_b32 v112, v12
  v_perm_b32 v12, v117, v113, s46
  v_perm_b32 v117, v117, v113, s47
  v_mov_b32 v113, v12
  v_perm_b32 v12, v118, v114, s46
  v_perm_b32 v118, v118, v114, s47
  v_mov_b32 v114, v12
  v_perm_b32 v12, v119, v115, s46
  v_perm_b32 v119, v119, v115, s47
  v_mov_b32 v115, v12
  s_waitcnt vmcnt(1)
  buffer_load_dwordx4 v[128:131], v5, s[32:35], s40 offen offset:2048
  s_waitcnt vmcnt(1)
  buffer_load_dwordx4 v[132:135], v5, s[32:35], s40 offen offset:3072
  s_add_u32 s40, s40, 4096
  v_perm_b32 v12, v124, v120, s46
  v_perm_b32 v124, v124, v120, s47
  v_mov_b32 v120, v12
  v_perm_b32 v12, v125, v121, s46
  v_perm_b32 v125, v125, v121, s47
  v_mov_b32 v121, v12
  v_perm_b32 v12, v126, v122, s46
  v_perm_b32 v126, v126, v122, s47
  v_mov_b32 v122, v12
  v_perm_b32 v12, v127, v123, s46
  v_perm_b32 v127, v127, v123, s47
  v_mov_b32 v123, v12
  s_waitcnt vmcnt(1)
  buffer_load_dwordx4 v[136:139], v5, s[32:35], s40 offen offset:0
  s_waitcnt vmcnt(1)
  buffer_load_dwordx4 v[140:143], v5, s[32:35], s40 offen offset:1024
  v_perm_b32 v12, v132, v128, s46
  v_perm_b32 v132, v132, v128, s47
  v_mov_b32 v128, v12
  v_perm_b32 v12, v133, v129, s46
  v_perm_b32 v133, v133, v129, s47
  v_mov_b32 v129, v12
  v_perm_b32 v12, v134, v130, s46
  v_perm_b32 v134, v134, v130, s47
  v_mov_b32 v130, v12
  v_perm_b32 v12, v135, v131, s46
  v_perm_b32 v135, v135, v131, s47
  v_mov_b32 v131, v12
  s_waitcnt vmcnt(1)
  buffer_load_dwordx4 v[144:147], v5, s[32:35], s40 offen offset:2048
  s_waitcnt vmcnt(1)
  buffer_load_dwordx4 v[148:151], v5, s[32:35], s40 offen offset:3072
  s_add_u32 s40, s40, 4096
  v_perm_b32 v12, v140, v136, s46
  v_perm_b32 v140, v140, v136, s47
  v_mov_b32 v136, v12
  v_perm_b32 v12, v141, v137, s46
  v_perm_b32 v141, v141, v137, s47
  v_mov_b32 v137, v12
  v_perm_b32 v12, v142, v138, s46
  v_perm_b32 v142, v142, v138, s47
  v_mov_b32 v138, v12
  v_perm_b32 v12, v143, v139, s46
  v_perm_b32 v143, v143, v139, s47
  v_mov_b32 v139, v12
  s_waitcnt vmcnt(1)
  buffer_load_dwordx4 v[152:155], v5, s[32:35], s40 offen offset:0
  s_waitcnt vmcnt(1)
  buffer_load_dwordx4 v[156:159], v5, s[32:35], s40 offen offset:1024
  v_perm_b32 v12, v148, v144, s46
  v_perm_b32 v148, v148, v144, s47
  v_mov_b32 v144, v12
  v_perm_b32 v12, v149, v145, s46
  v_perm_b32 v149, v149, v145, s47
  v_mov_b32 v145, v12
  v_perm_b32 v12, v150, v146, s46
  v_perm_b32 v150, v150, v146, s47
  v_mov_b32 v146, v12
  v_perm_b32 v12, v151, v147, s46
  v_perm_b32 v151, v151, v147, s47
  v_mov_b32 v147, v12
  s_waitcnt vmcnt(1)
  buffer_load_dwordx4 v[160:163], v5, s[32:35], s40 offen offset:2048
  s_waitcnt vmcnt(1)
  buffer_load_dwordx4 v[164:167], v5, s[32:35], s40 offen offset:3072
  s_add_u32 s40, s40, 4096
  v_perm_b32 v12, v156, v152, s46
  v_perm_b32 v156, v156, v152, s47
  v_mov_b32 v152, v12
  v_perm_b32 v12, v157, v153, s46
  v_perm_b32 v157, v157, v153, s47
  v_mov_b32 v153, v12
  v_perm_b32 v12, v158, v154, s46
  v_perm_b32 v158, v158, v154, s47
  v_mov_b32 v154, v12
  v_perm_b32 v12, v159, v155, s46
  v_perm_b32 v159, v159, v155, s47
  v_mov_b32 v155, v12
  s_waitcnt vmcnt(1)
  s_waitcnt vmcnt(0)
  v_perm_b32 v12, v164, v160, s46
  v_perm_b32 v164, v164, v160, s47
  v_mov_b32 v160, v12
  v_perm_b32 v12, v165, v161, s46
  v_perm_b32 v165, v165, v161, s47
  v_mov_b32 v161, v12
  v_perm_b32 v12, v166, v162, s46
  v_perm_b32 v166, v166, v162, s47
  v_mov_b32 v162, v12
  v_perm_b32 v12, v167, v163, s46
  v_perm_b32 v167, v167, v163, s47
  v_mov_b32 v163, v12
  v_lshrrev_b32 v7, 1, v1
  v_add_u32 v7, 147456, v7
  s_lshl_b32 s45, s3, 8
  s_add_u32 s45, s45, 150784
  v_lshrrev_b32 v4, 2, v1
  v_add_u32 v4, s45, v4
  v_lshlrev_b32 v3, 6, v3
  v_add_u32 v3, s45, v3
  v_bfe_u32 v0, v35, 0, 1
  v_bfe_u32 v1, v35, 1, 1
  v_bfe_u32 v2, v35, 2, 1
  v_bfe_u32 v5, v35, 3, 1
  v_mov_b32 v8, 0
  v_mov_b32 v9, 0
  v_mov_b32 v10, 0
  v_mov_b32 v11, 0
  v_mov_b32 v12, 0
  v_mov_b32 v13, 0
  v_mov_b32 v14, 0
  v_mov_b32 v15, 0
  s_barrier
  ds_read_b64 v[16:17], v7 offset:1024
  ds_read_b64 v[18:19], v7 offset:1536
  ds_read_b64 v[20:21], v7 offset:2048
  ds_read_b64 v[22:23], v7 offset:2560
  s_waitcnt lgkmcnt(2)
  v_add_f32 v16, v16, v18
  v_add_f32 v17, v17, v19
  s_waitcnt lgkmcnt(0)
  v_add_f32 v20, v20, v22
  v_add_f32 v21, v21, v23
  v_add_f32 v16, v16, v20
  v_add_f32 v17, v17, v21
  v_cvt_pk_bf16_f32 v25, v16, v17
  s_nop 1
  v_dot2c_f32_bf16_dpp v8, v25, v40 row_newbcast:0 row_mask:0xf bank_mask:0xf
  v_dot2c_f32_bf16_dpp v9, v25, v44 row_newbcast:0 row_mask:0xf bank_mask:0xf
  v_dot2c_f32_bf16_dpp v10, v25, v41 row_newbcast:0 row_mask:0xf bank_mask:0xf
  v_dot2c_f32_bf16_dpp v11, v25, v45 row_newbcast:0 row_mask:0xf bank_mask:0xf
  v_dot2c_f32_bf16_dpp v12, v25, v42 row_newbcast:0 row_mask:0xf bank_mask:0xf
  v_dot2c_f32_bf16_dpp v13, v25, v46 row_newbcast:0 row_mask:0xf bank_mask:0xf
  v_dot2c_f32_bf16_dpp v14, v25, v43 row_newbcast:0 row_mask:0xf bank_mask:0xf
  v_dot2c_f32_bf16_dpp v15, v25, v47 row_newbcast:0 row_mask:0xf bank_mask:0xf
  v_dot2c_f32_bf16_dpp v8, v25, v48 row_newbcast:1 row_mask:0xf bank_mask:0xf
  v_dot2c_f32_bf16_dpp v9, v25, v52 row_newbcast:1 row_mask:0xf bank_mask:0xf
  v_dot2c_f32_bf16_dpp v10, v25, v49 row_newbcast:1 row_mask:0xf bank_mask:0xf
  v_dot2c_f32_bf16_dpp v11, v25, v53 row_newbcast:1 row_mask:0xf bank_mask:0xf
  v_dot2c_f32_bf16_dpp v12, v25, v50 row_newbcast:1 row_mask:0xf bank_mask:0xf
  v_dot2c_f32_bf16_dpp v13, v25, v54 row_newbcast:1 row_mask:0xf bank_mask:0xf
  v_dot2c_f32_bf16_dpp v14, v25, v51 row_newbcast:1 row_mask:0xf bank_mask:0xf
  v_dot2c_f32_bf16_dpp v15, v25, v55 row_newbcast:1 row_mask:0xf bank_mask:0xf
  v_dot2c_f32_bf16_dpp v8, v25, v56 row_newbcast:2 row_mask:0xf bank_mask:0xf
  v_dot2c_f32_bf16_dpp v9, v25, v60 row_newbcast:2 row_mask:0xf bank_mask:0xf
  v_dot2c_f32_bf16_dpp v10, v25, v57 row_newbcast:2 row_mask:0xf bank_mask:0xf
  v_dot2c_f32_bf16_dpp v11, v25, v61 row_newbcast:2 row_mask:0xf bank_mask:0xf
  v_dot2c_f32_bf16_dpp v12, v25, v58 row_newbcast:2 row_mask:0xf bank_mask:0xf
  v_dot2c_f32_bf16_dpp v13, v25, v62 row_newbcast:2 row_mask:0xf bank_mask:0xf
  v_dot2c_f32_bf16_dpp v14, v25, v59 row_newbcast:2 row_mask:0xf bank_mask:0xf
  v_dot2c_f32_bf16_dpp v15, v25, v63 row_newbcast:2 row_mask:0xf bank_mask:0xf
  v_dot2c_f32_bf16_dpp v8, v25, v64 row_newbcast:3 row_mask:0xf bank_mask:0xf
  v_dot2c_f32_bf16_dpp v9, v25, v68 row_newbcast:3 row_mask:0xf bank_mask:0xf
  v_dot2c_f32_bf16_dpp v10, v25, v65 row_newbcast:3 row_mask:0xf bank_mask:0xf
  v_dot2c_f32_bf16_dpp v11, v25, v69 row_newbcast:3 row_mask:0xf bank_mask:0xf
  v_dot2c_f32_bf16_dpp v12, v25, v66 row_newbcast:3 row_mask:0xf bank_mask:0xf
  v_dot2c_f32_bf16_dpp v13, v25, v70 row_newbcast:3 row_mask:0xf bank_mask:0xf
  v_dot2c_f32_bf16_dpp v14, v25, v67 row_newbcast:3 row_mask:0xf bank_mask:0xf
  v_dot2c_f32_bf16_dpp v15, v25, v71 row_newbcast:3 row_mask:0xf bank_mask:0xf
  v_dot2c_f32_bf16_dpp v8, v25, v72 row_newbcast:4 row_mask:0xf bank_mask:0xf
  v_dot2c_f32_bf16_dpp v9, v25, v76 row_newbcast:4 row_mask:0xf bank_mask:0xf
  v_dot2c_f32_bf16_dpp v10, v25, v73 row_newbcast:4 row_mask:0xf bank_mask:0xf
  v_dot2c_f32_bf16_dpp v11, v25, v77 row_newbcast:4 row_mask:0xf bank_mask:0xf
  v_dot2c_f32_bf16_dpp v12, v25, v74 row_newbcast:4 row_mask:0xf bank_mask:0xf
  v_dot2c_f32_bf16_dpp v13, v25, v78 row_newbcast:4 row_mask:0xf bank_mask:0xf
  v_dot2c_f32_bf16_dpp v14, v25, v75 row_newbcast:4 row_mask:0xf bank_mask:0xf
  v_dot2c_f32_bf16_dpp v15, v25, v79 row_newbcast:4 row_mask:0xf bank_mask:0xf
  v_dot2c_f32_bf16_dpp v8, v25, v80 row_newbcast:5 row_mask:0xf bank_mask:0xf
  v_dot2c_f32_bf16_dpp v9, v25, v84 row_newbcast:5 row_mask:0xf bank_mask:0xf
  v_dot2c_f32_bf16_dpp v10, v25, v81 row_newbcast:5 row_mask:0xf bank_mask:0xf
  v_dot2c_f32_bf16_dpp v11, v25, v85 row_newbcast:5 row_mask:0xf bank_mask:0xf
  v_dot2c_f32_bf16_dpp v12, v25, v82 row_newbcast:5 row_mask:0xf bank_mask:0xf
  v_dot2c_f32_bf16_dpp v13, v25, v86 row_newbcast:5 row_mask:0xf bank_mask:0xf
  v_dot2c_f32_bf16_dpp v14, v25, v83 row_newbcast:5 row_mask:0xf bank_mask:0xf
  v_dot2c_f32_bf16_dpp v15, v25, v87 row_newbcast:5 row_mask:0xf bank_mask:0xf
  v_dot2c_f32_bf16_dpp v8, v25, v88 row_newbcast:6 row_mask:0xf bank_mask:0xf
  v_dot2c_f32_bf16_dpp v9, v25, v92 row_newbcast:6 row_mask:0xf bank_mask:0xf
  v_dot2c_f32_bf16_dpp v10, v25, v89 row_newbcast:6 row_mask:0xf bank_mask:0xf
  v_dot2c_f32_bf16_dpp v11, v25, v93 row_newbcast:6 row_mask:0xf bank_mask:0xf
  v_dot2c_f32_bf16_dpp v12, v25, v90 row_newbcast:6 row_mask:0xf bank_mask:0xf
  v_dot2c_f32_bf16_dpp v13, v25, v94 row_newbcast:6 row_mask:0xf bank_mask:0xf
  v_dot2c_f32_bf16_dpp v14, v25, v91 row_newbcast:6 row_mask:0xf bank_mask:0xf
  v_dot2c_f32_bf16_dpp v15, v25, v95 row_newbcast:6 row_mask:0xf bank_mask:0xf
  v_dot2c_f32_bf16_dpp v8, v25, v96 row_newbcast:7 row_mask:0xf bank_mask:0xf
  v_dot2c_f32_bf16_dpp v9, v25, v100 row_newbcast:7 row_mask:0xf bank_mask:0xf
  v_dot2c_f32_bf16_dpp v10, v25, v97 row_newbcast:7 row_mask:0xf bank_mask:0xf
  v_dot2c_f32_bf16_dpp v11, v25, v101 row_newbcast:7 row_mask:0xf bank_mask:0xf
  v_dot2c_f32_bf16_dpp v12, v25, v98 row_newbcast:7 row_mask:0xf bank_mask:0xf
  v_dot2c_f32_bf16_dpp v13, v25, v102 row_newbcast:7 row_mask:0xf bank_mask:0xf
  v_dot2c_f32_bf16_dpp v14, v25, v99 row_newbcast:7 row_mask:0xf bank_mask:0xf
  v_dot2c_f32_bf16_dpp v15, v25, v103 row_newbcast:7 row_mask:0xf bank_mask:0xf
  v_dot2c_f32_bf16_dpp v8, v25, v104 row_newbcast:8 row_mask:0xf bank_mask:0xf
  v_dot2c_f32_bf16_dpp v9, v25, v108 row_newbcast:8 row_mask:0xf bank_mask:0xf
  v_dot2c_f32_bf16_dpp v10, v25, v105 row_newbcast:8 row_mask:0xf bank_mask:0xf
  v_dot2c_f32_bf16_dpp v11, v25, v109 row_newbcast:8 row_mask:0xf bank_mask:0xf
  v_dot2c_f32_bf16_dpp v12, v25, v106 row_newbcast:8 row_mask:0xf bank_mask:0xf
  v_dot2c_f32_bf16_dpp v13, v25, v110 row_newbcast:8 row_mask:0xf bank_mask:0xf
  v_dot2c_f32_bf16_dpp v14, v25, v107 row_newbcast:8 row_mask:0xf bank_mask:0xf
  v_dot2c_f32_bf16_dpp v15, v25, v111 row_newbcast:8 row_mask:0xf bank_mask:0xf
  v_dot2c_f32_bf16_dpp v8, v25, v112 row_newbcast:9 row_mask:0xf bank_mask:0xf
  v_dot2c_f32_bf16_dpp v9, v25, v116 row_newbcast:9 row_mask:0xf bank_mask:0xf
  v_dot2c_f32_bf16_dpp v10, v25, v113 row_newbcast:9 row_mask:0xf bank_mask:0xf
  v_dot2c_f32_bf16_dpp v11, v25, v117 row_newbcast:9 row_mask:0xf bank_mask:0xf
  v_dot2c_f32_bf16_dpp v12, v25, v114 row_newbcast:9 row_mask:0xf bank_mask:0xf
  v_dot2c_f32_bf16_dpp v13, v25, v118 row_newbcast:9 row_mask:0xf bank_mask:0xf
  v_dot2c_f32_bf16_dpp v14, v25, v115 row_newbcast:9 row_mask:0xf bank_mask:0xf
  v_dot2c_f32_bf16_dpp v15, v25, v119 row_newbcast:9 row_mask:0xf bank_mask:0xf
  v_dot2c_f32_bf16_dpp v8, v25, v120 row_newbcast:10 row_mask:0xf bank_mask:0xf
  v_dot2c_f32_bf16_dpp v9, v25, v124 row_newbcast:10 row_mask:0xf bank_mask:0xf
  v_dot2c_f32_bf16_dpp v10, v25, v121 row_newbcast:10 row_mask:0xf bank_mask:0xf
  v_dot2c_f32_bf16_dpp v11, v25, v125 row_newbcast:10 row_mask:0xf bank_mask:0xf
  v_dot2c_f32_bf16_dpp v12, v25, v122 row_newbcast:10 row_mask:0xf bank_mask:0xf
  v_dot2c_f32_bf16_dpp v13, v25, v126 row_newbcast:10 row_mask:0xf bank_mask:0xf
  v_dot2c_f32_bf16_dpp v14, v25, v123 row_newbcast:10 row_mask:0xf bank_mask:0xf
  v_dot2c_f32_bf16_dpp v15, v25, v127 row_newbcast:10 row_mask:0xf bank_mask:0xf
  v_dot2c_f32_bf16_dpp v8, v25, v128 row_newbcast:11 row_mask:0xf bank_mask:0xf
  v_dot2c_f32_bf16_dpp v9, v25, v132 row_newbcast:11 row_mask:0xf bank_mask:0xf
  v_dot2c_f32_bf16_dpp v10, v25, v129 row_newbcast:11 row_mask:0xf bank_mask:0xf
  v_dot2c_f32_bf16_dpp v11, v25, v133 row_newbcast:11 row_mask:0xf bank_mask:0xf
  v_dot2c_f32_bf16_dpp v12, v25, v130 row_newbcast:11 row_mask:0xf bank_mask:0xf
  v_dot2c_f32_bf16_dpp v13, v25, v134 row_newbcast:11 row_mask:0xf bank_mask:0xf
  v_dot2c_f32_bf16_dpp v14, v25, v131 row_newbcast:11 row_mask:0xf bank_mask:0xf
  v_dot2c_f32_bf16_dpp v15, v25, v135 row_newbcast:11 row_mask:0xf bank_mask:0xf
  v_dot2c_f32_bf16_dpp v8, v25, v136 row_newbcast:12 row_mask:0xf bank_mask:0xf
  v_dot2c_f32_bf16_dpp v9, v25, v140 row_newbcast:12 row_mask:0xf bank_mask:0xf
  v_dot2c_f32_bf16_dpp v10, v25, v137 row_newbcast:12 row_mask:0xf bank_mask:0xf
  v_dot2c_f32_bf16_dpp v11, v25, v141 row_newbcast:12 row_mask:0xf bank_mask:0xf
  v_dot2c_f32_bf16_dpp v12, v25, v138 row_newbcast:12 row_mask:0xf bank_mask:0xf
  v_dot2c_f32_bf16_dpp v13, v25, v142 row_newbcast:12 row_mask:0xf bank_mask:0xf
  v_dot2c_f32_bf16_dpp v14, v25, v139 row_newbcast:12 row_mask:0xf bank_mask:0xf
  v_dot2c_f32_bf16_dpp v15, v25, v143 row_newbcast:12 row_mask:0xf bank_mask:0xf
  v_dot2c_f32_bf16_dpp v8, v25, v144 row_newbcast:13 row_mask:0xf bank_mask:0xf
  v_dot2c_f32_bf16_dpp v9, v25, v148 row_newbcast:13 row_mask:0xf bank_mask:0xf
  v_dot2c_f32_bf16_dpp v10, v25, v145 row_newbcast:13 row_mask:0xf bank_mask:0xf
  v_dot2c_f32_bf16_dpp v11, v25, v149 row_newbcast:13 row_mask:0xf bank_mask:0xf
  v_dot2c_f32_bf16_dpp v12, v25, v146 row_newbcast:13 row_mask:0xf bank_mask:0xf
  v_dot2c_f32_bf16_dpp v13, v25, v150 row_newbcast:13 row_mask:0xf bank_mask:0xf
  v_dot2c_f32_bf16_dpp v14, v25, v147 row_newbcast:13 row_mask:0xf bank_mask:0xf
  v_dot2c_f32_bf16_dpp v15, v25, v151 row_newbcast:13 row_mask:0xf bank_mask:0xf
  v_dot2c_f32_bf16_dpp v8, v25, v152 row_newbcast:14 row_mask:0xf bank_mask:0xf
  v_dot2c_f32_bf16_dpp v9, v25, v156 row_newbcast:14 row_mask:0xf bank_mask:0xf
  v_dot2c_f32_bf16_dpp v10, v25, v153 row_newbcast:14 row_mask:0xf bank_mask:0xf
  v_dot2c_f32_bf16_dpp v11, v25, v157 row_newbcast:14 row_mask:0xf bank_mask:0xf
  v_dot2c_f32_bf16_dpp v12, v25, v154 row_newbcast:14 row_mask:0xf bank_mask:0xf
  v_dot2c_f32_bf16_dpp v13, v25, v158 row_newbcast:14 row_mask:0xf bank_mask:0xf
  v_dot2c_f32_bf16_dpp v14, v25, v155 row_newbcast:14 row_mask:0xf bank_mask:0xf
  v_dot2c_f32_bf16_dpp v15, v25, v159 row_newbcast:14 row_mask:0xf bank_mask:0xf
  v_dot2c_f32_bf16_dpp v8, v25, v160 row_newbcast:15 row_mask:0xf bank_mask:0xf
  v_dot2c_f32_bf16_dpp v9, v25, v164 row_newbcast:15 row_mask:0xf bank_mask:0xf
  v_dot2c_f32_bf16_dpp v10, v25, v161 row_newbcast:15 row_mask:0xf bank_mask:0xf
  v_dot2c_f32_bf16_dpp v11, v25, v165 row_newbcast:15 row_mask:0xf bank_mask:0xf
  v_dot2c_f32_bf16_dpp v12, v25, v162 row_newbcast:15 row_mask:0xf bank_mask:0xf
  v_dot2c_f32_bf16_dpp v13, v25, v166 row_newbcast:15 row_mask:0xf bank_mask:0xf
  v_dot2c_f32_bf16_dpp v14, v25, v163 row_newbcast:15 row_mask:0xf bank_mask:0xf
  v_dot2c_f32_bf16_dpp v15, v25, v167 row_newbcast:15 row_mask:0xf bank_mask:0xf
  s_nop 2
  v_permlane32_swap_b32 v8, v12
  v_permlane32_swap_b32 v9, v13
  v_permlane32_swap_b32 v10, v14
  v_permlane32_swap_b32 v11, v15
  v_add_f32 v8, v8, v12
  v_add_f32 v9, v9, v13
  v_add_f32 v10, v10, v14
  v_add_f32 v11, v11, v15
  v_mov_b32 v12, v8
  v_mov_b32 v13, v9
  v_mov_b32 v14, v10
  v_mov_b32 v15, v11
  v_permlane16_swap_b32 v8, v12
  v_permlane16_swap_b32 v9, v13
  v_permlane16_swap_b32 v10, v14
  v_permlane16_swap_b32 v11, v15
  v_add_f32 v8, v8, v12
  v_add_f32 v9, v9, v13
  v_add_f32 v10, v10, v14
  v_add_f32 v11, v11, v15
  v_and_or_b32 v20, v8, -2, v0
  v_and_or_b32 v21, v9, -2, v1
  v_and_or_b32 v22, v10, -2, v2
  v_and_or_b32 v23, v11, -2, v5
  s_mov_b32 exec_lo, 0xffff
  s_mov_b32 exec_hi, 0xffff
  buffer_store_dwordx4 v[20:23], v34, s[48:51], s14 offen sc1
  s_endpgm
L_notwo:
  s_cmp_eq_u32 s3, 5
  s_cbranch_scc1 L_ctl
  s_add_u32 s52, s48, 524288
  s_addc_u32 s53, s49, 0
  s_mov_b32 s54, 57344
  s_mov_b32 s55, 0x20000
  s_add_u32 s28, s4, s39
  s_addc_u32 s29, s5, 0
  s_add_u32 s56, s22, s39
  s_addc_u32 s57, s23, 0
  s_mov_b32 s58, 1024
  s_mov_b32 s59, 0x20000
  v_lshrrev_b32 v32, 2, v2
  v_lshlrev_b32 v32, 11, v32
  v_and_b32 v33, 48, v1
  v_add_u32 v32, v32, v33
  v_add_u32 v33, 0x8000, v32
  v_lshlrev_b32 v34, 1, v1
  s_lshl_b32 s14, s36, 11
  s_lshl_b32 s15, s36, 6
  v_lshrrev_b32 v31, 1, v1
  v_and_b32 v31, 24, v31
  s_lshl_b32 s46, s36, 5
  v_add_u32 v31, s46, v31
  buffer_load_dwordx4 v[8:11], v32, s[48:51], s15 offen sc1
  buffer_load_dwordx4 v[12:15], v33, s[48:51], s15 offen sc1
  buffer_load_dwordx4 v[16:19], v32, s[52:55], s15 offen sc1
  buffer_load_dwordx4 v[20:23], v33, s[52:55], s15 offen sc1
  s_lshl_b32 s46, s37, 5
  v_mov_b32 v30, s46
  v_mov_b32 v29, 1
  v_cmp_le_u32 vcc, 48, v2
  s_waitcnt vmcnt(0)
  s_mov_b64 exec, 1
  global_atomic_add v30, v29, s[24:25] sc1
  s_mov_b64 exec, -1
  v_and_b32 v36, 1, v8
  v_and_b32 v24, 1, v9
  v_lshl_or_b32 v36, v24, 1, v36
  v_and_b32 v24, 1, v10
  v_lshl_or_b32 v36, v24, 2, v36
  v_and_b32 v24, 1, v11
  v_lshl_or_b32 v36, v24, 3, v36
  v_and_b32 v24, 1, v12
  v_lshl_or_b32 v36, v24, 4, v36
  v_and_b32 v24, 1, v13
  v_lshl_or_b32 v36, v24, 5, v36
  v_and_b32 v24, 1, v14
  v_lshl_or_b32 v36, v24, 6, v36
  v_and_b32 v24, 1, v15
  v_lshl_or_b32 v36, v24, 7, v36
  v_and_b32 v37, 1, v16
  v_and_b32 v24, 1, v17
  v_lshl_or_b32 v37, v24, 1, v37
  v_and_b32 v24, 1, v18
  v_lshl_or_b32 v37, v24, 2, v37
  v_and_b32 v24, 1, v19
  v_lshl_or_b32 v37, v24, 3, v37
  v_and_b32 v24, 1, v20
  v_lshl_or_b32 v37, v24, 4, v37
  v_and_b32 v24, 1, v21
  v_lshl_or_b32 v37, v24, 5, v37
  v_and_b32 v24, 1, v22
  v_lshl_or_b32 v37, v24, 6, v37
  v_and_b32 v24, 1, v23
  v_lshl_or_b32 v37, v24, 7, v37
  v_mov_b32 v24, 0xf0
  v_cndmask_b32 v24, 0, v24, vcc
  v_or_b32 v37, v37, v24
L_hq:
  ds_read_b32 v39, v38 offset:4
  s_waitcnt lgkmcnt(0)
  v_readfirstlane_b32 s45, v39
  s_cmp_ge_u32 s45, 4
  s_cbranch_scc1 L_hq_ok
  s_sleep 8
  s_branch L_hq
L_hq_ok:
  buffer_load_dwordx4 v[8:11], v34, s[52:55], s14 offen sc1
  buffer_load_dwordx4 v[12:15], v34, s[52:55], s14 offen offset:16 sc1
  buffer_load_dwordx2 v[26:27], v31, s[28:31], 0 offen
  s_waitcnt vmcnt(0)
  v_and_b32 v35, 1, v8
  v_and_b32 v24, 1, v9
  v_lshl_or_b32 v35, v24, 1, v35
  v_and_b32 v24, 1, v10
  v_lshl_or_b32 v35, v24, 2, v35
  v_and_b32 v24, 1, v11
  v_lshl_or_b32 v35, v24, 3, v35
  v_and_b32 v24, 1, v12
  v_lshl_or_b32 v35, v24, 4, v35
  v_and_b32 v24, 1, v13
  v_lshl_or_b32 v35, v24, 5, v35
  v_and_b32 v24, 1, v14
  v_lshl_or_b32 v35, v24, 6, v35
  v_and_b32 v24, 1, v15
  v_lshl_or_b32 v35, v24, 7, v35
  v_xor_b32 v35, 0xff, v35
  s_cmp_ge_u32 s36, 28
  s_cbranch_scc1 L_noffn
L_ff0:
  ds_read_b32 v39, v38 offset:0
  s_waitcnt lgkmcnt(0)
  v_readfirstlane_b32 s45, v39
  s_cmp_ge_u32 s45, 70
  s_cbranch_scc1 L_ff0_ok
  s_sleep 16
  s_branch L_ff0
L_ff0_ok:
  s_mov_b32 s28, s16
  s_mov_b32 s29, s17
  s_mov_b32 s30, 0x1c0000
  s_mov_b32 s32, s18
  s_mov_b32 s33, s19
  s_mov_b32 s34, 0x1c0000
  v_lshrrev_b32 v6, 3, v2
  v_and_b32 v7, 7, v2
  s_mov_b32 s46, 229376
  v_mul_lo_u32 v8, v6, s46
  v_lshl_add_u32 v8, v7, 4, v8
  s_lshl_b32 s46, s36, 7
  v_add_u32 v8, s46, v8
  v_lshlrev_b32 v9, 7, v6
  v_add_u32 v9, 147456, v9
  s_mov_b32 s40, 0
  buffer_load_dwordx4 v[56:59], v8, s[28:31], s40 offen offset:0
  buffer_load_dwordx4 v[60:63], v8, s[32:35], s40 offen offset:0
  buffer_load_dwordx4 v[64:67], v8, s[28:31], s40 offen offset:3584
  s_mov_b32 s41, 7168
  ds_read_b32 v10, v9
  v_mov_b32 v40, 0
  v_mov_b32 v41, 0
  v_mov_b32 v42, 0
  v_mov_b32 v43, 0
  v_mov_b32 v44, 0
  v_mov_b32 v45, 0
  v_mov_b32 v46, 0
  v_mov_b32 v47, 0
  v_mov_b32 v48, 0
  v_mov_b32 v49, 0
  v_mov_b32 v50, 0
  v_mov_b32 v51, 0
  v_mov_b32 v52, 0
  v_mov_b32 v53, 0
  v_mov_b32 v54, 0
  v_mov_b32 v55, 0
  s_mov_b32 s44, 31
L_floop:
  s_waitcnt lgkmcnt(0)
  v_and_b32 v12, 0xffff, v10
  v_lshlrev_b32 v13, 16, v10
  v_lshrrev_b32 v14, 16, v10
  v_and_b32 v15, s43, v10
  v_add_u32 v9, 4, v9
  ds_read_b32 v10, v9
  s_waitcnt vmcnt(2)
  v_dot2c_f32_bf16 v40, v56, v12
  v_dot2c_f32_bf16 v41, v56, v13
  v_dot2c_f32_bf16 v42, v57, v12
  v_dot2c_f32_bf16 v43, v57, v13
  v_dot2c_f32_bf16 v44, v58, v12
  v_dot2c_f32_bf16 v45, v58, v13
  v_dot2c_f32_bf16 v46, v59, v12
  v_dot2c_f32_bf16 v47, v59, v13
  buffer_load_dwordx4 v[68:71], v8, s[32:35], s40 offen offset:3584
  s_waitcnt vmcnt(2)
  v_dot2c_f32_bf16 v48, v60, v12
  v_dot2c_f32_bf16 v49, v60, v13
  v_dot2c_f32_bf16 v50, v61, v12
  v_dot2c_f32_bf16 v51, v61, v13
  v_dot2c_f32_bf16 v52, v62, v12
  v_dot2c_f32_bf16 v53, v62, v13
  v_dot2c_f32_bf16 v54, v63, v12
  v_dot2c_f32_bf16 v55, v63, v13
  buffer_load_dwordx4 v[56:59], v8, s[28:31], s41 offen offset:0
  s_waitcnt vmcnt(2)
  v_dot2c_f32_bf16 v40, v64, v14
  v_dot2c_f32_bf16 v41, v64, v15
  v_dot2c_f32_bf16 v42, v65, v14
  v_dot2c_f32_bf16 v43, v65, v15
  v_dot2c_f32_bf16 v44, v66, v14
  v_dot2c_f32_bf16 v45, v66, v15
  v_dot2c_f32_bf16 v46, v67, v14
  v_dot2c_f32_bf16 v47, v67, v15
  buffer_load_dwordx4 v[60:63], v8, s[32:35], s41 offen offset:0
  s_waitcnt vmcnt(2)
  v_dot2c_f32_bf16 v48, v68, v14
  v_dot2c_f32_bf16 v49, v68, v15
  v_dot2c_f32_bf16 v50, v69, v14
  v_dot2c_f32_bf16 v51, v69, v15
  v_dot2c_f32_bf16 v52, v70, v14
  v_dot2c_f32_bf16 v53, v70, v15
  v_dot2c_f32_bf16 v54, v71, v14
  v_dot2c_f32_bf16 v55, v71, v15
  buffer_load_dwordx4 v[64:67], v8, s[28:31], s41 offen offset:3584
  s_mov_b32 s40, s41
  s_add_u32 s41, s41, 7168
  s_sub_u32 s44, s44, 1
  s_cmp_lg_u32 s44, 0
  s_cbranch_scc1 L_floop
  s_waitcnt lgkmcnt(0)
  v_and_b32 v12, 0xffff, v10
  v_lshlrev_b32 v13, 16, v10
  v_lshrrev_b32 v14, 16, v10
  v_and_b32 v15, s43, v10
  s_waitcnt vmcnt(2)
  v_dot2c_f32_bf16 v40, v56, v12
  v_dot2c_f32_bf16 v41, v56, v13
  v_dot2c_f32_bf16 v42, v57, v12
  v_dot2c_f32_bf16 v43, v57, v13
  v_dot2c_f32_bf16 v44, v58, v12
  v_dot2c_f32_bf16 v45, v58, v13
  v_dot2c_f32_bf16 v46, v59, v12
  v_dot2c_f32_bf16 v47, v59, v13
  buffer_load_dwordx4 v[68:71], v8, s[32:35], s40 offen offset:3584
  s_waitcnt vmcnt(2)
  v_dot2c_f32_bf16 v48, v60, v12
  v_dot2c_f32_bf16 v49, v60, v13
  v_dot2c_f32_bf16 v50, v61, v12
  v_dot2c_f32_bf16 v51, v61, v13
  v_dot2c_f32_bf16 v52, v62, v12
  v_dot2c_f32_bf16 v53, v62, v13
  v_dot2c_f32_bf16 v54, v63, v12
  v_dot2c_f32_bf16 v55, v63, v13
  s_waitcnt vmcnt(1)
  v_dot2c_f32_bf16 v40, v64, v14
  v_dot2c_f32_bf16 v41, v64, v15
  v_dot2c_f32_bf16 v42, v65, v14
  v_dot2c_f32_bf16 v43, v65, v15
  v_dot2c_f32_bf16 v44, v66, v14
  v_dot2c_f32_bf16 v45, v66, v15
  v_dot2c_f32_bf16 v46, v67, v14
  v_dot2c_f32_bf16 v47, v67, v15
  s_waitcnt vmcnt(0)
  v_dot2c_f32_bf16 v48, v68, v14
  v_dot2c_f32_bf16 v49, v68, v15
  v_dot2c_f32_bf16 v50, v69, v14
  v_dot2c_f32_bf16 v51, v69, v15
  v_dot2c_f32_bf16 v52, v70, v14
  v_dot2c_f32_bf16 v53, v70, v15
  v_dot2c_f32_bf16 v54, v71, v14
  v_dot2c_f32_bf16 v55, v71, v15
  s_mov_b32 s28, s20
  s_mov_b32 s29, s21
  s_lshl_b32 s40, s36, 16
  s_add_u32 s41, s40, 4096
  buffer_load_dwordx4 v[56:59], v1, s[28:31], s40 offen offset:0
  buffer_load_dwordx4 v[60:63], v1, s[28:31], s40 offen offset:1024
  buffer_load_dwordx4 v[64:67], v1, s[28:31], s40 offen offset:2048
  v_and_b32 v14, 8, v2
  v_cmp_ne_u32 vcc, 0, v14
  v_permlane32_swap_b32 v40, v44
  v_permlane32_swap_b32 v41, v45
  v_permlane32_swap_b32 v42, v46
  v_permlane32_swap_b32 v43, v47
  v_add_f32 v40, v40, v44
  v_add_f32 v41, v41, v45
  v_add_f32 v42, v42, v46
  v_add_f32 v43, v43, v47
  s_nop 0
  v_permlane16_swap_b32 v40, v42
  v_permlane16_swap_b32 v41, v43
  v_add_f32 v40, v40, v42
  v_add_f32 v41, v41, v43
  s_nop 1
  v_add_f32_dpp v40, v40, v40 row_ror:8 row_mask:0xf bank_mask:0xf
  v_add_f32_dpp v41, v41, v41 row_ror:8 row_mask:0xf bank_mask:0xf
  v_cndmask_b32 v40, v40, v41, vcc
  v_permlane32_swap_b32 v48, v52
  v_permlane32_swap_b32 v49, v53
  v_permlane32_swap_b32 v50, v54
  v_permlane32_swap_b32 v51, v55
  v_add_f32 v48, v48, v52
  v_add_f32 v49, v49, v53
  v_add_f32 v50, v50, v54
  v_add_f32 v51, v51, v55
  s_nop 0
  v_permlane16_swap_b32 v48, v50
  v_permlane16_swap_b32 v49, v51
  v_add_f32 v48, v48, v50
  v_add_f32 v49, v49, v51
  s_nop 1
  v_add_f32_dpp v48, v48, v48 row_ror:8 row_mask:0xf bank_mask:0xf
  v_add_f32_dpp v49, v49, v49 row_ror:8 row_mask:0xf bank_mask:0xf
  v_cndmask_b32 v48, v48, v49, vcc
  v_cvt_pk_bf16_f32 v14, v40, v48
  v_lshlrev_b32 v15, 16, v14
  v_and_b32 v16, s43, v14
  v_mul_f32 v17, v15, v15
  v_mul_f32 v17, v17, v15
  v_mov_b32 v18, 0x3d372713
  v_fma_f32 v17, v17, v18, v15
  v_mul_f32 v17, 0xc0135761, v17
  v_exp_f32 v17, v17
  s_nop 0
  v_add_f32 v17, 1.0, v17
  v_rcp_f32 v17, v17
  s_nop 0
  v_mul_f32 v17, v15, v17
  v_cvt_pk_bf16_f32 v17, v17, v17
  v_and_b32 v17, s43, v17
  v_mul_f32 v17, v17, v16
  v_cvt_pk_bf16_f32 v17, v17, v17
  v_lshlrev_b32 v14, 4, v7
  v_lshrrev_b32 v15, 5, v2
  v_lshl_add_u32 v14, v15, 3, v14
  v_bfe_u32 v15, v2, 4, 1
  v_lshl_add_u32 v14, v15, 2, v14
  v_bfe_u32 v15, v2, 3, 1
  v_lshl_add_u32 v14, v15, 1, v14
  v_mov_b32 v9, 151808
  v_add_u32 v14, v9, v14
  ds_write_b16 v14, v17
  s_waitcnt lgkmcnt(0)
  ds_read_b64 v[10:11], v9
  v_mov_b32 v40, 0
  v_mov_b32 v41, 0
  v_mov_b32 v42, 0
  v_mov_b32 v43, 0
  v_mov_b32 v44, 0
  v_mov_b32 v45, 0
  v_mov_b32 v46, 0
  v_mov_b32 v47, 0
  s_mov_b32 s44, 15
L_dloop:
  s_waitcnt lgkmcnt(0)
  v_and_b32 v12, 0xffff, v10
  v_lshlrev_b32 v13, 16, v10
  v_lshrrev_b32 v14, 16, v10
  v_and_b32 v15, s43, v10
  v_and_b32 v16, 0xffff, v11
  v_lshlrev_b32 v17, 16, v11
  v_lshrrev_b32 v18, 16, v11
  v_and_b32 v19, s43, v11
  v_add_u32 v9, 8, v9
  ds_read_b64 v[10:11], v9
  s_waitcnt vmcnt(2)
  v_dot2c_f32_bf16 v40, v56, v12
  v_dot2c_f32_bf16 v41, v56, v13
  v_dot2c_f32_bf16 v42, v57, v12
  v_dot2c_f32_bf16 v43, v57, v13
  v_dot2c_f32_bf16 v44, v58, v12
  v_dot2c_f32_bf16 v45, v58, v13
  v_dot2c_f32_bf16 v46, v59, v12
  v_dot2c_f32_bf16 v47, v59, v13
  buffer_load_dwordx4 v[68:71], v1, s[28:31], s40 offen offset:3072
  s_waitcnt vmcnt(2)
  v_dot2c_f32_bf16 v40, v60, v14
  v_dot2c_f32_bf16 v41, v60, v15
  v_dot2c_f32_bf16 v42, v61, v14
  v_dot2c_f32_bf16 v43, v61, v15
  v_dot2c_f32_bf16 v44, v62, v14
  v_dot2c_f32_bf16 v45, v62, v15
  v_dot2c_f32_bf16 v46, v63, v14
  v_dot2c_f32_bf16 v47, v63, v15
  buffer_load_dwordx4 v[56:59], v1, s[28:31], s41 offen offset:0
  s_waitcnt vmcnt(2)
  v_dot2c_f32_bf16 v40, v64, v16
  v_dot2c_f32_bf16 v41, v64, v17
  v_dot2c_f32_bf16 v42, v65, v16
  v_dot2c_f32_bf16 v43, v65, v17
  v_dot2c_f32_bf16 v44, v66, v16
  v_dot2c_f32_bf16 v45, v66, v17
  v_dot2c_f32_bf16 v46, v67, v16
  v_dot2c_f32_bf16 v47, v67, v17
  buffer_load_dwordx4 v[60:63], v1, s[28:31], s41 offen offset:1024
  s_waitcnt vmcnt(2)
  v_dot2c_f32_bf16 v40, v68, v18
  v_dot2c_f32_bf16 v41, v68, v19
  v_dot2c_f32_bf16 v42, v69, v18
  v_dot2c_f32_bf16 v43, v69, v19
  v_dot2c_f32_bf16 v44, v70, v18
  v_dot2c_f32_bf16 v45, v70, v19
  v_dot2c_f32_bf16 v46, v71, v18
  v_dot2c_f32_bf16 v47, v71, v19
  buffer_load_dwordx4 v[64:67], v1, s[28:31], s41 offen offset:2048
  s_mov_b32 s40, s41
  s_add_u32 s41, s41, 4096
  s_sub_u32 s44, s44, 1
  s_cmp_lg_u32 s44, 0
  s_cbranch_scc1 L_dloop
  s_waitcnt lgkmcnt(0)
  v_and_b32 v12, 0xffff, v10
  v_lshlrev_b32 v13, 16, v10
  v_lshrrev_b32 v14, 16, v10
  v_and_b32 v15, s43, v10
  v_and_b32 v16, 0xffff, v11
  v_lshlrev_b32 v17, 16, v11
  v_lshrrev_b32 v18, 16, v11
  v_and_b32 v19, s43, v11
  s_waitcnt vmcnt(2)
  v_dot2c_f32_bf16 v40, v56, v12
  v_dot2c_f32_bf16 v41, v56, v13
  v_dot2c_f32_bf16 v42, v57, v12
  v_dot2c_f32_bf16 v43, v57, v13
  v_dot2c_f32_bf16 v44, v58, v12
  v_dot2c_f32_bf16 v45, v58, v13
  v_dot2c_f32_bf16 v46, v59, v12
  v_dot2c_f32_bf16 v47, v59, v13
  buffer_load_dwordx4 v[68:71], v1, s[28:31], s40 offen offset:3072
  s_waitcnt vmcnt(2)
  v_dot2c_f32_bf16 v40, v60, v14
  v_dot2c_f32_bf16 v41, v60, v15
  v_dot2c_f32_bf16 v42, v61, v14
  v_dot2c_f32_bf16 v43, v61, v15
  v_dot2c_f32_bf16 v44, v62, v14
  v_dot2c_f32_bf16 v45, v62, v15
  v_dot2c_f32_bf16 v46, v63, v14
  v_dot2c_f32_bf16 v47, v63, v15
  s_waitcnt vmcnt(1)
  v_dot2c_f32_bf16 v40, v64, v16
  v_dot2c_f32_bf16 v41, v64, v17
  v_dot2c_f32_bf16 v42, v65, v16
  v_dot2c_f32_bf16 v43, v65, v17
  v_dot2c_f32_bf16 v44, v66, v16
  v_dot2c_f32_bf16 v45, v66, v17
  v_dot2c_f32_bf16 v46, v67, v16
  v_dot2c_f32_bf16 v47, v67, v17
  s_waitcnt vmcnt(0)
  v_dot2c_f32_bf16 v40, v68, v18
  v_dot2c_f32_bf16 v41, v68, v19
  v_dot2c_f32_bf16 v42, v69, v18
  v_dot2c_f32_bf16 v43, v69, v19
  v_dot2c_f32_bf16 v44, v70, v18
  v_dot2c_f32_bf16 v45, v70, v19
  v_dot2c_f32_bf16 v46, v71, v18
  v_dot2c_f32_bf16 v47, v71, v19
  v_bfe_u32 v8, v35, 0, 1
  v_bfe_u32 v9, v35, 1, 1
  v_bfe_u32 v10, v35, 2, 1
  v_bfe_u32 v11, v35, 3, 1
  v_bfe_u32 v12, v35, 4, 1
  v_bfe_u32 v13, v35, 5, 1
  v_bfe_u32 v14, v35, 6, 1
  v_bfe_u32 v15, v35, 7, 1
  v_and_or_b32 v40, v40, -2, v8
  v_and_or_b32 v41, v41, -2, v9
  v_and_or_b32 v42, v42, -2, v10
  v_and_or_b32 v43, v43, -2, v11
  v_and_or_b32 v44, v44, -2, v12
  v_and_or_b32 v45, v45, -2, v13
  v_and_or_b32 v46, v46, -2, v14
  v_and_or_b32 v47, v47, -2, v15
L_noffn:
L_mid:
  ds_read_b32 v39, v38 offset:0
  s_waitcnt lgkmcnt(0)
  v_readfirstlane_b32 s45, v39
  s_cmp_ge_u32 s45, 440
  s_cbranch_scc1 L_mid_ok
  s_sleep 32
  s_branch L_mid
L_mid_ok:
  s_mov_b32 s47, 0x20000
  s_mov_b64 exec, 1
L_rdy:
  global_load_dword v13, v30, s[24:25] sc1
  s_waitcnt vmcnt(0)
  v_readfirstlane_b32 s46, v13
  s_sub_u32 s47, s47, 1
  s_cmp_eq_u32 s47, 0
  s_cbranch_scc1 L_rdy_ok
  s_cmp_ge_u32 s46, 32
  s_cbranch_scc1 L_rdy_ok
  s_sleep 16
  s_branch L_rdy
L_rdy_ok:
  s_mov_b64 exec, -1
  v_lshlrev_b32 v24, 16, v26
  v_and_b32 v25, s43, v26
  v_lshlrev_b32 v26, 16, v27
  v_and_b32 v27, s43, v27
  v_cmp_gt_u32 vcc, 32, v2
  v_and_b32 v12, 16, v2
  v_cmp_eq_u32 s[12:13], 0, v12
  s_nop 0
  v_cndmask_b32 v24, v26, v24, vcc
  v_cndmask_b32 v25, v27, v25, vcc
  v_cndmask_b32 v24, v25, v24, s[12:13]
  v_lshrrev_b32 v12, 5, v2
  v_lshl_add_u32 v31, v12, 2, v31
  v_bfe_u32 v12, v2, 4, 1
  v_lshl_add_u32 v31, v12, 1, v31
  v_bfe_u32 v48, v36, 0, 1
  v_bfe_u32 v49, v36, 1, 1
  v_bfe_u32 v50, v36, 2, 1
  v_bfe_u32 v51, v36, 3, 1
  v_bfe_u32 v52, v36, 4, 1
  v_bfe_u32 v53, v36, 5, 1
  v_bfe_u32 v54, v36, 6, 1
  v_bfe_u32 v55, v36, 7, 1
  v_bfe_u32 v56, v37, 0, 1
  v_bfe_u32 v57, v37, 1, 1
  v_bfe_u32 v58, v37, 2, 1
  v_bfe_u32 v59, v37, 3, 1
  v_bfe_u32 v60, v37, 4, 1
  v_bfe_u32 v61, v37, 5, 1
  v_bfe_u32 v62, v37, 6, 1
  v_bfe_u32 v63, v37, 7, 1
  s_mov_b32 s47, 0x40000
L_yp:
  ds_read_b32 v39, v38 offset:0
  s_waitcnt lgkmcnt(0)
  v_readfirstlane_b32 s45, v39
  s_cmp_ge_u32 s45, 506
  s_cbranch_scc1 L_yp_ok
  s_sleep 2
  s_branch L_yp
L_yp_ok:
  buffer_store_dwordx4 v[40:43], v34, s[52:55], s14 offen sc1
  buffer_store_dwordx4 v[44:47], v34, s[52:55], s14 offen offset:16 sc1
  s_barrier
L_gy:
  buffer_load_dwordx4 v[64:67], v32, s[52:55], s15 offen sc1
  buffer_load_dwordx4 v[68:71], v33, s[52:55], s15 offen sc1
L_gy1:
  s_waitcnt vmcnt(0)
  v_xor_b32 v16, v64, v56
  v_bitop3_b32 v16, v16, v65, v57 bitop3:0x60
  v_bitop3_b32 v16, v16, v66, v58 bitop3:0x60
  v_bitop3_b32 v16, v16, v67, v59 bitop3:0x60
  v_bitop3_b32 v16, v16, v68, v60 bitop3:0x60
  v_bitop3_b32 v16, v16, v69, v61 bitop3:0x60
  v_bitop3_b32 v16, v16, v70, v62 bitop3:0x60
  v_bitop3_b32 v16, v16, v71, v63 bitop3:0x60
  v_and_b32 v16, 1, v16
  v_cmp_eq_u32 vcc, 0, v16
  s_sub_u32 s47, s47, 1
  s_cmp_eq_u32 s47, 0
  s_cbranch_scc1 L_gy_ok
  s_and_b64 exec, exec, vcc
  s_cbranch_scc1 L_gy
L_gy_ok:
  s_mov_b64 exec, -1
  buffer_load_dwordx4 v[72:75], v32, s[48:51], s15 offen sc1
  buffer_load_dwordx4 v[76:79], v33, s[48:51], s15 offen sc1
  v_and_b32 v8, -2, v64
  v_and_b32 v9, -2, v65
  v_and_b32 v10, -2, v66
  v_and_b32 v11, -2, v67
  v_and_b32 v12, -2, v68
  v_and_b32 v13, -2, v69
  v_and_b32 v14, -2, v70
  v_and_b32 v15, -2, v71
  v_add_f32 v8, v8, v12
  v_add_f32 v9, v9, v13
  v_add_f32 v10, v10, v14
  v_add_f32 v11, v11, v15
  s_nop 0
  v_permlane32_swap_b32 v8, v10
  v_permlane32_swap_b32 v9, v11
  v_add_f32 v8, v8, v10
  v_add_f32 v9, v9, v11
  s_nop 1
  v_permlane16_swap_b32 v8, v9
  v_add_f32 v8, v8, v9
  s_nop 1
  v_add_f32_dpp v8, v8, v8 row_ror:4 row_mask:0xf bank_mask:0xf
  s_nop 1
  v_add_f32_dpp v8, v8, v8 row_ror:8 row_mask:0xf bank_mask:0xf
  v_cvt_pk_bf16_f32 v8, 0, v8
  v_mul_f32 v9, 0xbfb8aa3b, v8
  v_exp_f32 v9, v9
  s_nop 0
  v_add_f32 v9, 1.0, v9
  v_rcp_f32 v9, v9
  s_nop 0
  v_mul_f32 v8, v8, v9
  v_cvt_pk_bf16_f32 v20, 0, v8
  s_mov_b32 s47, 0x40000
  s_branch L_gs1
L_gs:
  buffer_load_dwordx4 v[72:75], v32, s[48:51], s15 offen sc1
  buffer_load_dwordx4 v[76:79], v33, s[48:51], s15 offen sc1
L_gs1:
  s_waitcnt vmcnt(0)
  v_xor_b32 v16, v72, v48
  v_bitop3_b32 v16, v16, v73, v49 bitop3:0x60
  v_bitop3_b32 v16, v16, v74, v50 bitop3:0x60
  v_bitop3_b32 v16, v16, v75, v51 bitop3:0x60
  v_bitop3_b32 v16, v16, v76, v52 bitop3:0x60
  v_bitop3_b32 v16, v16, v77, v53 bitop3:0x60
  v_bitop3_b32 v16, v16, v78, v54 bitop3:0x60
  v_bitop3_b32 v16, v16, v79, v55 bitop3:0x60
  v_and_b32 v16, 1, v16
  v_cmp_eq_u32 vcc, 0, v16
  s_sub_u32 s47, s47, 1
  s_cmp_eq_u32 s47, 0
  s_cbranch_scc1 L_gs_ok
  s_and_b64 exec, exec, vcc
  s_cbranch_scc1 L_gs
L_gs_ok:
  s_mov_b64 exec, -1
  v_and_b32 v8, -2, v72
  v_and_b32 v9, -2, v73
  v_and_b32 v10, -2, v74
  v_and_b32 v11, -2, v75
  v_and_b32 v12, -2, v76
  v_and_b32 v13, -2, v77
  v_and_b32 v14, -2, v78
  v_and_b32 v15, -2, v79
  v_add_f32 v8, v8, v12
  v_add_f32 v9, v9, v13
  v_add_f32 v10, v10, v14
  v_add_f32 v11, v11, v15
  s_nop 0
  v_permlane32_swap_b32 v8, v10
  v_permlane32_swap_b32 v9, v11
  v_add_f32 v8, v8, v10
  v_add_f32 v9, v9, v11
  s_nop 1
  v_permlane16_swap_b32 v8, v9
  v_add_f32 v8, v8, v9
  s_nop 1
  v_add_f32_dpp v8, v8, v8 row_ror:4 row_mask:0xf bank_mask:0xf
  s_nop 1
  v_add_f32_dpp v8, v8, v8 row_ror:8 row_mask:0xf bank_mask:0xf
  v_cvt_pk_bf16_f32 v8, 0, v8
  v_mul_f32 v8, v8, v20
  v_cvt_pk_bf16_f32 v8, 0, v8
  v_add_f32 v8, v8, v24
  v_cvt_pk_bf16_f32 v8, v8, v8
  s_mov_b32 exec_lo, 0x000f000f
  s_mov_b32 exec_hi, 0x000f000f
  buffer_store_short v8, v31, s[56:59], 0 offen
L_done:
  s_endpgm
L_ctl:
  s_and_b32 s12, s2, 7
  s_lshr_b32 s13, s2, 3
  s_lshl_b32 s46, s12, 12
  s_add_u32 s46, s46, 1048576
  s_add_u32 s28, s26, s46
  s_addc_u32 s29, s27, 0
  s_mov_b32 s30, 4096
  s_add_u32 s32, s26, 1081344
  s_addc_u32 s33, s27, 0
  s_mov_b32 s34, 4096
  s_lshl_b32 s46, s13, 2
  v_mov_b32 v7, s46
  s_lshl_b32 s46, s12, 2
  v_mov_b32 v6, s46
  s_mov_b32 s44, 32
  s_mov_b32 s40, 0
  s_mov_b32 s50, 0
  s_mov_b32 s51, 0
  s_mov_b32 s56, 0
  v_mov_b32 v20, 0
  s_mov_b64 exec, 1
L_cl:
L_cp:
  ds_read_b32 v39, v38 offset:0
  s_waitcnt lgkmcnt(0)
  v_readfirstlane_b32 s45, v39
  s_cmp_ge_u32 s45, s44
  s_cbranch_scc1 L_cp_ok
  s_sleep 2
  s_branch L_cp
L_cp_ok:
  s_memrealtime s[48:49]
  s_waitcnt lgkmcnt(0)
  v_mov_b32 v8, s48
  buffer_store_dword v8, v7, s[28:31], s40 offen
  s_cmp_eq_u32 s40, 0
  s_cbranch_scc1 L_cnext
  s_sub_u32 s41, s40, 128
  s_load_dwordx16 s[64:79], s[28:29], s41
  s_add_u32 s46, s41, 64
  s_load_dwordx16 s[80:95], s[28:29], s46
  s_cmp_eq_u32 s41, 0
  s_cbranch_scc1 L_cn2
  s_sub_u32 s46, s41, 128
  s_load_dwordx8 s[4:11], s[32:33], s46
L_cn2:
  s_mov_b32 s52, 0
  s_mov_b32 s53, 0
  s_sub_u32 s54, s50, 2000
  s_waitcnt lgkmcnt(0)
  s_sub_u32 s55, s64, s54
  s_cmp_lt_u32 s55, 4000
  s_cselect_b32 s55, s55, 2000
  s_addc_u32 s53, s53, 0
  s_add_u32 s52, s52, s55
  s_sub_u32 s55, s65, s54
  s_cmp_lt_u32 s55, 4000
  s_cselect_b32 s55, s55, 2000
  s_addc_u32 s53, s53, 0
  s_add_u32 s52, s52, s55
  s_sub_u32 s55, s66, s54
  s_cmp_lt_u32 s55, 4000
  s_cselect_b32 s55, s55, 2000
  s_addc_u32 s53, s53, 0
  s_add_u32 s52, s52, s55
  s_sub_u32 s55, s67, s54
  s_cmp_lt_u32 s55, 4000
  s_cselect_b32 s55, s55, 2000
  s_addc_u32 s53, s53, 0
  s_add_u32 s52, s52, s55
  s_sub_u32 s55, s68, s54
  s_cmp_lt_u32 s55, 4000
  s_cselect_b32 s55, s55, 2000
  s_addc_u32 s53, s53, 0
  s_add_u32 s52, s52, s55
  s_sub_u32 s55, s69, s54
  s_cmp_lt_u32 s55, 4000
  s_cselect_b32 s55, s55, 2000
  s_addc_u32 s53, s53, 0
  s_add_u32 s52, s52, s55
  s_sub_u32 s55, s70, s54
  s_cmp_lt_u32 s55, 4000
  s_cselect_b32 s55, s55, 2000
  s_addc_u32 s53, s53, 0
  s_add_u32 s52, s52, s55
  s_sub_u32 s55, s71, s54
  s_cmp_lt_u32 s55, 4000
  s_cselect_b32 s55, s55, 2000
  s_addc_u32 s53, s53, 0
  s_add_u32 s52, s52, s55
  s_sub_u32 s55, s72, s54
  s_cmp_lt_u32 s55, 4000
  s_cselect_b32 s55, s55, 2000
  s_addc_u32 s53, s53, 0
  s_add_u32 s52, s52, s55
  s_sub_u32 s55, s73, s54
  s_cmp_lt_u32 s55, 4000
  s_cselect_b32 s55, s55, 2000
  s_addc_u32 s53, s53, 0
  s_add_u32 s52, s52, s55
  s_sub_u32 s55, s74, s54
  s_cmp_lt_u32 s55, 4000
  s_cselect_b32 s55, s55, 2000
  s_addc_u32 s53, s53, 0
  s_add_u32 s52, s52, s55
  s_sub_u32 s55, s75, s54
  s_cmp_lt_u32 s55, 4000
  s_cselect_b32 s55, s55, 2000
  s_addc_u32 s53, s53, 0
  s_add_u32 s52, s52, s55
  s_sub_u32 s55, s76, s54
  s_cmp_lt_u32 s55, 4000
  s_cselect_b32 s55, s55, 2000
  s_addc_u32 s53, s53, 0
  s_add_u32 s52, s52, s55
  s_sub_u32 s55, s77, s54
  s_cmp_lt_u32 s55, 4000
  s_cselect_b32 s55, s55, 2000
  s_addc_u32 s53, s53, 0
  s_add_u32 s52, s52, s55
  s_sub_u32 s55, s78, s54
  s_cmp_lt_u32 s55, 4000
  s_cselect_b32 s55, s55, 2000
  s_addc_u32 s53, s53, 0
  s_add_u32 s52, s52, s55
  s_sub_u32 s55, s79, s54
  s_cmp_lt_u32 s55, 4000
  s_cselect_b32 s55, s55, 2000
  s_addc_u32 s53, s53, 0
  s_add_u32 s52, s52, s55
  s_sub_u32 s55, s80, s54
  s_cmp_lt_u32 s55, 4000
  s_cselect_b32 s55, s55, 2000
  s_addc_u32 s53, s53, 0
  s_add_u32 s52, s52, s55
  s_sub_u32 s55, s81, s54
  s_cmp_lt_u32 s55, 4000
  s_cselect_b32 s55, s55, 2000
  s_addc_u32 s53, s53, 0
  s_add_u32 s52, s52, s55
  s_sub_u32 s55, s82, s54
  s_cmp_lt_u32 s55, 4000
  s_cselect_b32 s55, s55, 2000
  s_addc_u32 s53, s53, 0
  s_add_u32 s52, s52, s55
  s_sub_u32 s55, s83, s54
  s_cmp_lt_u32 s55, 4000
  s_cselect_b32 s55, s55, 2000
  s_addc_u32 s53, s53, 0
  s_add_u32 s52, s52, s55
  s_sub_u32 s55, s84, s54
  s_cmp_lt_u32 s55, 4000
  s_cselect_b32 s55, s55, 2000
  s_addc_u32 s53, s53, 0
  s_add_u32 s52, s52, s55
  s_sub_u32 s55, s85, s54
  s_cmp_lt_u32 s55, 4000
  s_cselect_b32 s55, s55, 2000
  s_addc_u32 s53, s53, 0
  s_add_u32 s52, s52, s55
  s_sub_u32 s55, s86, s54
  s_cmp_lt_u32 s55, 4000
  s_cselect_b32 s55, s55, 2000
  s_addc_u32 s53, s53, 0
  s_add_u32 s52, s52, s55
  s_sub_u32 s55, s87, s54
  s_cmp_lt_u32 s55, 4000
  s_cselect_b32 s55, s55, 2000
  s_addc_u32 s53, s53, 0
  s_add_u32 s52, s52, s55
  s_sub_u32 s55, s88, s54
  s_cmp_lt_u32 s55, 4000
  s_cselect_b32 s55, s55, 2000
  s_addc_u32 s53, s53, 0
  s_add_u32 s52, s52, s55
  s_sub_u32 s55, s89, s54
  s_cmp_lt_u32 s55, 4000
  s_cselect_b32 s55, s55, 2000
  s_addc_u32 s53, s53, 0
  s_add_u32 s52, s52, s55
  s_sub_u32 s55, s90, s54
  s_cmp_lt_u32 s55, 4000
  s_cselect_b32 s55, s55, 2000
  s_addc_u32 s53, s53, 0
  s_add_u32 s52, s52, s55
  s_sub_u32 s55, s91, s54
  s_cmp_lt_u32 s55, 4000
  s_cselect_b32 s55, s55, 2000
  s_addc_u32 s53, s53, 0
  s_add_u32 s52, s52, s55
  s_sub_u32 s55, s92, s54
  s_cmp_lt_u32 s55, 4000
  s_cselect_b32 s55, s55, 2000
  s_addc_u32 s53, s53, 0
  s_add_u32 s52, s52, s55
  s_sub_u32 s55, s93, s54
  s_cmp_lt_u32 s55, 4000
  s_cselect_b32 s55, s55, 2000
  s_addc_u32 s53, s53, 0
  s_add_u32 s52, s52, s55
  s_sub_u32 s55, s94, s54
  s_cmp_lt_u32 s55, 4000
  s_cselect_b32 s55, s55, 2000
  s_addc_u32 s53, s53, 0
  s_add_u32 s52, s52, s55
  s_sub_u32 s55, s95, s54
  s_cmp_lt_u32 s55, 4000
  s_cselect_b32 s55, s55, 2000
  s_addc_u32 s53, s53, 0
  s_add_u32 s52, s52, s55
  s_sub_u32 s52, s52, 64000
  s_max_u32 s53, s53, 1
  v_cvt_f32_i32 v11, s52
  v_cvt_f32_u32 v12, s53
  v_rcp_f32 v12, v12
  s_mov_b32 s52, 0
  s_mov_b32 s53, 0
  s_sub_u32 s54, s56, 2000
  s_sub_u32 s55, s4, s54
  s_cmp_lt_u32 s55, 4000
  s_cselect_b32 s55, s55, 2000
  s_addc_u32 s53, s53, 0
  s_add_u32 s52, s52, s55
  s_sub_u32 s55, s5, s54
  s_cmp_lt_u32 s55, 4000
  s_cselect_b32 s55, s55, 2000
  s_addc_u32 s53, s53, 0
  s_add_u32 s52, s52, s55
  s_sub_u32 s55, s6, s54
  s_cmp_lt_u32 s55, 4000
  s_cselect_b32 s55, s55, 2000
  s_addc_u32 s53, s53, 0
  s_add_u32 s52, s52, s55
  s_sub_u32 s55, s7, s54
  s_cmp_lt_u32 s55, 4000
  s_cselect_b32 s55, s55, 2000
  s_addc_u32 s53, s53, 0
  s_add_u32 s52, s52, s55
  s_sub_u32 s55, s8, s54
  s_cmp_lt_u32 s55, 4000
  s_cselect_b32 s55, s55, 2000
  s_addc_u32 s53, s53, 0
  s_add_u32 s52, s52, s55
  s_sub_u32 s55, s9, s54
  s_cmp_lt_u32 s55, 4000
  s_cselect_b32 s55, s55, 2000
  s_addc_u32 s53, s53, 0
  s_add_u32 s52, s52, s55
  s_sub_u32 s55, s10, s54
  s_cmp_lt_u32 s55, 4000
  s_cselect_b32 s55, s55, 2000
  s_addc_u32 s53, s53, 0
  s_add_u32 s52, s52, s55
  s_sub_u32 s55, s11, s54
  s_cmp_lt_u32 s55, 4000
  s_cselect_b32 s55, s55, 2000
  s_addc_u32 s53, s53, 0
  s_add_u32 s52, s52, s55
  s_sub_u32 s52, s52, 16000
  s_max_u32 s53, s53, 1
  v_mul_f32 v11, v11, v12
  v_cvt_f32_i32 v13, s52
  v_cvt_f32_u32 v14, s53
  v_rcp_f32 v14, v14
  v_cvt_i32_f32 v12, v11
  v_add_u32 v12, s50, v12
  v_mul_f32 v13, v13, v14
  v_readfirstlane_b32 s57, v12
  s_lshr_b32 s46, s40, 7
  s_cmp_lg_u32 s13, s46
  s_cbranch_scc1 L_cnl
  buffer_store_dword v12, v6, s[32:35], s41 offen sc1
L_cnl:
  s_sub_u32 s46, s48, s50
  s_sub_u32 s47, s57, s56
  s_cmp_eq_u32 s41, 0
  s_cselect_b32 s46, s46, s47
  v_cvt_f32_i32 v14, s46
  v_rcp_f32 v14, v14
  s_mov_b32 s56, s57
  v_mul_f32 v11, 0xbf000000, v11
  v_mul_f32 v13, 0xbf000000, v13
  v_add_f32 v11, v11, v13
  v_mov_b32 v15, 0x439e0000
  v_mul_f32 v11, v11, v14
  v_mul_f32 v13, 0x3f266666, v11
  v_min_f32 v11, v11, v13
  v_fma_f32 v15, v15, v11, v15
  v_max_f32 v15, 0x43500000, v15
  v_min_f32 v15, 0x43e00000, v15
  v_cvt_u32_f32 v15, v15
  ds_write_b32 v38, v15 offset:12
L_cnext:
  s_mov_b32 s50, s48
  s_cmp_ge_u32 s44, 384
  s_cselect_b32 s46, 16, 32
  s_add_u32 s44, s44, s46
  s_add_u32 s40, s40, 128
  s_cmp_le_u32 s44, 496
  s_cbranch_scc1 L_cl
  s_endpgm
.p2align 10
L_end:
.section .rodata,"a"
.p2align 6
.amdhsa_kernel recurrent_scan__mha_block_cached__geglu_ffn__decode_kernel
  .amdhsa_next_free_vgpr 168
  .amdhsa_next_free_sgpr 96
  .amdhsa_accum_offset 168
  .amdhsa_group_segment_fixed_size 0
  .amdhsa_kernarg_size 96
  .amdhsa_user_sgpr_count 2
  .amdhsa_user_sgpr_kernarg_segment_ptr 1
  .amdhsa_system_sgpr_workgroup_id_x 1
  .amdhsa_float_denorm_mode_32 3
.end_amdhsa_kernel
```
